```python
import torch

def _softmax(x, axis=-1):
    return torch.softmax(x, dim=axis)
def _gelu(x):
    return torch.nn.functional.gelu(x, approximate="tanh")
def _silu(x):
    return torch.nn.functional.silu(x)
def _sigmoid(x):
    return torch.sigmoid(x)
def _layernorm(x, axis=-1, eps=1e-5):
    m = x.mean(dim=axis, keepdim=True)
    v = x.var(dim=axis, keepdim=True, unbiased=False)
    return (x - m) / torch.sqrt(v + eps)
def _scatter_add(tgt, idx, src, axis=0):
    return tgt.clone().index_add_(axis, idx, src)
def _segment_sum(src, seg, n):
    out = torch.zeros((n,) + src.shape[1:], dtype=src.dtype)
    return out.index_add_(0, seg, src)
def _pad(x, pw):
    flat = tuple(v for pair in reversed(pw) for v in pair)
    return torch.nn.functional.pad(x, flat)

kernel_name = 'sequential_preLN__sliding_block__dense_activation_relu__prompt'

def setup_inputs():

    _w = (lambda a: (lambda t: t.to(torch.bfloat16) if t.is_floating_point() else t)(torch.as_tensor(a)))
    def _A_setup():
        B, S, D = 1, 2048, 448
        return {
            "x": _w((lambda *s: torch.randn(*s, dtype=torch.bfloat16) * 0.05)(B, S, D)),
            "wqkv": _w((lambda *s: torch.randn(*s, dtype=torch.bfloat16) * 0.05)(D, 3 * D)),
            "wo": _w((lambda *s: torch.randn(*s, dtype=torch.bfloat16) * 0.05)(D, D)),
        }
    _A_in = _A_setup()

    def _B_setup():
        B, S, D, Dff = 1, 2048, 448, 1792
        return {
            "x": _w((lambda *s: torch.randn(*s, dtype=torch.bfloat16) * 0.05)(B, S, D)),
            "w1": _w((lambda *s: torch.randn(*s, dtype=torch.bfloat16) * 0.05)(D, Dff)),
            "w2": _w((lambda *s: torch.randn(*s, dtype=torch.bfloat16) * 0.05)(Dff, D)),
        }
    _B_in = _B_setup()

    return {
        "A_x": _A_in["x"],
        "A_wqkv": _A_in["wqkv"],
        "A_wo": _A_in["wo"],
        "B_x": _B_in["x"],
        "B_w1": _B_in["w1"],
        "B_w2": _B_in["w2"],
    }

def reference(A_x, A_wqkv, A_wo, B_x, B_w1, B_w2):
    def _A_ref(x, wqkv, wo):
        B, S, D = x.shape
        H = 16; Dh = D // H; W = 256
        qkv = (lambda x, *d: x.permute(*d))((x @ wqkv).reshape(B, S, 3, H, Dh), 2, 0, 3, 1, 4)
        q, k, v = qkv[0], qkv[1], qkv[2]
        scores = torch.einsum("bhqd,bhkd->bhqk", q, k) * (Dh ** -0.5)
        idx = torch.arange(S)
        mask = (idx[:, None] - idx[None, :] >= 0) & (idx[:, None] - idx[None, :] < W)
        scores = torch.where(mask[None, None], scores, -1e9)
        p = _softmax(scores, axis=-1)
        o = torch.einsum("bhqk,bhkd->bhqd", p, v)
        return (lambda x, *d: x.permute(*d))(o, 0, 2, 1, 3).reshape(B, S, D) @ wo

    def _B_ref(x, w1, w2):
        h = torch.einsum("bsd,df->bsf", x, w1)
        zero = torch.zeros_like(h)
        h = torch.maximum(h, zero)
        return torch.einsum("bsf,fd->bsd", h, w2)

    x = A_x
    h = x + _A_ref(_layernorm(x, axis=-1), A_wqkv, A_wo)
    h2 = h + _B_ref(_layernorm(h, axis=-1), B_w1, B_w2)
    return h2
```

```asm
; @launch grid=(256,1,1) block=(512,1,1) lds=163840
.amdgcn_target "amdgcn-amd-amdhsa--gfx950"
.text
.globl sequential_preLN__sliding_block__dense_activation_relu__prompt_kernel
.p2align 8
.type sequential_preLN__sliding_block__dense_activation_relu__prompt_kernel,@function
sequential_preLN__sliding_block__dense_activation_relu__prompt_kernel:
  s_load_dwordx16 s[72:87], s[0:1], 0
  s_load_dwordx2 s[88:89], s[0:1], 64
  s_getpc_b64 s[90:91]
Lpc:
  v_and_b32 v1, 63, v0
  v_lshrrev_b32 v7, 6, v0
  s_lshr_b32 s59, s2, 3
  v_readfirstlane_b32 s38, v7
  v_lshlrev_b32 v18, 7, v1
  s_cmp_ge_u32 s2, 256
  s_nop 2
  s_cbranch_scc1 Lend
  s_add_u32 s60, s59, s38
  s_and_b32 s60, s60, 7
  s_lshl_b32 s60, s60, 13
  v_add_u32 v18, s60, v18
  v_min_u32 v18, Lcode_end-Lpc-4, v18
  v_mov_b32 v19, s91
  v_add_co_u32 v18, vcc, s90, v18
  s_nop 1
  v_addc_co_u32 v19, vcc, 0, v19, vcc
  s_cmp_ge_u32 s38, 2
  s_nop 3
  s_cbranch_scc1 Lnocp
  global_load_dword v26, v[18:19], off
Lnocp:
  v_and_b32 v2, 31, v0
  v_bfe_u32 v3, v0, 5, 1
  v_and_b32 v4, 15, v0
  v_bfe_u32 v5, v0, 4, 2
  v_lshlrev_b32 v6, 4, v1
  v_mov_b32 v24, 0
  s_and_b32 s60, s2, 7
  s_lshr_b32 s62, s59, 4
  s_lshl_b32 s36, s60, 1
  s_add_u32 s36, s36, s62
  s_and_b32 s37, s59, 15
  s_lshl_b32 s39, s36, 7
  s_and_b32 s45, s38, 3
  s_lshl_b32 s56, s45, 10
  s_lshl_b32 s57, s45, 12
  s_mul_i32 s63, s62, 3
  s_add_u32 s44, s37, s63
  s_sub_u32 s63, s44, 7
  s_cmp_ge_u32 s44, 7
  s_cselect_b32 s44, s63, s44
  s_sub_u32 s63, s44, 7
  s_cmp_ge_u32 s44, 7
  s_cselect_b32 s44, s63, s44
  v_lshrrev_b32 v18, 3, v1
  s_lshl_b32 s60, s45, 5
  s_add_u32 s60, s60, s39
  v_add_u32 v18, s60, v18
  v_mul_u32_u24 v18, 896, v18
  v_and_b32 v19, 7, v1
  v_xor_b32 v19, v19, v5
  v_xor_b32 v20, 4, v19
  v_lshl_add_u32 v32, v19, 4, v18
  v_lshl_add_u32 v33, v20, 4, v18
  v_add_u32 v33, 7168, v33
  v_lshl_add_u32 v34, v19, 4, v18
  v_add_u32 v34, 14336, v34
  v_lshl_add_u32 v35, v20, 4, v18
  v_add_u32 v35, 21504, v35
  s_mul_i32 s60, s45, 43008
  s_mul_i32 s61, s37, 192
  s_add_u32 s60, s60, s61
  v_add_u32 v18, 0, v1
  v_mul_u32_u24 v19, 5462, v18
  v_lshrrev_b32 v19, 16, v19
  v_mul_u32_u24 v19, 2496, v19
  v_lshl_add_u32 v36, v18, 4, v19
  v_add_u32 v36, s60, v36
  v_add_u32 v18, 64, v1
  v_mul_u32_u24 v19, 5462, v18
  v_lshrrev_b32 v19, 16, v19
  v_mul_u32_u24 v19, 2496, v19
  v_lshl_add_u32 v37, v18, 4, v19
  v_add_u32 v37, s60, v37
  v_add_u32 v18, 128, v1
  v_mul_u32_u24 v19, 5462, v18
  v_lshrrev_b32 v19, 16, v19
  v_mul_u32_u24 v19, 2496, v19
  v_lshl_add_u32 v38, v18, 4, v19
  v_add_u32 v38, s60, v38
  s_mov_b32 s70, s44
  s_mov_b32 s71, s44
  s_mul_i32 s92, s45, 3072
  s_mov_b32 s6, 1835008
  s_mov_b32 s7, 0x00020000
  s_mov_b32 s10, 1204224
  s_mov_b32 s11, 0x00020000
  s_mov_b32 s14, 401408
  s_mov_b32 s15, 0x00020000
  s_mov_b32 s18, 1605632
  s_mov_b32 s19, 0x00020000
  s_mov_b32 s22, 1605632
  s_mov_b32 s23, 0x00020000
  s_mov_b32 s26, 1835008
  s_mov_b32 s27, 0x00020000
  s_mov_b32 s30, 256
  s_mov_b32 s31, 0x00020000
  s_mov_b32 s34, 33554432
  s_mov_b32 s35, 0x00020000
  s_waitcnt lgkmcnt(0)
  s_mov_b64 s[4:5], s[72:73]
  s_mov_b64 s[8:9], s[74:75]
  s_mov_b64 s[12:13], s[76:77]
  s_mov_b64 s[16:17], s[80:81]
  s_mov_b64 s[20:21], s[82:83]
  s_mov_b64 s[24:25], s[84:85]
  s_mov_b64 s[28:29], s[86:87]
  s_mov_b64 s[32:33], s[88:89]
  s_or_b32 s60, s2, s38
  s_cmp_lg_u32 s60, 0
  s_cbranch_scc1 Lnoep
  s_memrealtime s[94:95]
  s_waitcnt lgkmcnt(0)
  s_lshl_b32 s61, s94, 4
  s_or_b32 s61, s61, 8
  s_mul_i32 s62, s94, 0x9e3779b1
  s_add_u32 s62, s62, s95
  v_mov_b32 v18, s61
  v_mov_b32 v19, s62
  s_mov_b64 exec, 1
  buffer_store_dwordx2 v[18:19], v24, s[28:31], 0 offen sc1
  s_mov_b64 exec, -1
Lnoep:
  s_cmp_ge_u32 s37, 14
  s_cbranch_scc1 Lservice
  s_cmp_lt_u32 s38, 4
  s_cbranch_scc1 Lmfma
  s_mul_i32 s61, s71, 172032
  s_add_u32 m0, s92, 0
  s_nop 0
  buffer_load_dwordx4 v36, s[8:11], s61 offen lds
  s_add_u32 m0, s92, 1024
  s_nop 0
  buffer_load_dwordx4 v37, s[8:11], s61 offen lds
  s_add_u32 m0, s92, 2048
  s_nop 0
  buffer_load_dwordx4 v38, s[8:11], s61 offen lds
  s_add_u32 s71, s71, 1
  s_cmp_eq_u32 s71, 7
  s_cselect_b32 s71, 0, s71
  s_lshl_b32 s60, s70, 7
  s_add_u32 m0, s57, 86016
  s_nop 0
  buffer_load_dwordx4 v32, s[4:7], s60 offen lds
  s_add_u32 m0, s57, 87040
  s_nop 0
  buffer_load_dwordx4 v33, s[4:7], s60 offen lds
  s_add_u32 m0, s57, 88064
  s_nop 0
  buffer_load_dwordx4 v34, s[4:7], s60 offen lds
  s_add_u32 m0, s57, 89088
  s_nop 0
  buffer_load_dwordx4 v35, s[4:7], s60 offen lds
  s_add_u32 s70, s70, 1
  s_cmp_eq_u32 s70, 7
  s_cselect_b32 s70, 0, s70
  s_mul_i32 s61, s71, 172032
  s_add_u32 m0, s92, 12288
  s_nop 0
  buffer_load_dwordx4 v36, s[8:11], s61 offen lds
  s_add_u32 m0, s92, 13312
  s_nop 0
  buffer_load_dwordx4 v37, s[8:11], s61 offen lds
  s_add_u32 m0, s92, 14336
  s_nop 0
  buffer_load_dwordx4 v38, s[8:11], s61 offen lds
  s_add_u32 s71, s71, 1
  s_cmp_eq_u32 s71, 7
  s_cselect_b32 s71, 0, s71
  s_lshl_b32 s60, s70, 7
  s_add_u32 m0, s57, 102400
  s_nop 0
  buffer_load_dwordx4 v32, s[4:7], s60 offen lds
  s_add_u32 m0, s57, 103424
  s_nop 0
  buffer_load_dwordx4 v33, s[4:7], s60 offen lds
  s_add_u32 m0, s57, 104448
  s_nop 0
  buffer_load_dwordx4 v34, s[4:7], s60 offen lds
  s_add_u32 m0, s57, 105472
  s_nop 0
  buffer_load_dwordx4 v35, s[4:7], s60 offen lds
  s_add_u32 s70, s70, 1
  s_cmp_eq_u32 s70, 7
  s_cselect_b32 s70, 0, s70
  s_mul_i32 s61, s71, 172032
  s_add_u32 m0, s92, 24576
  s_nop 0
  buffer_load_dwordx4 v36, s[8:11], s61 offen lds
  s_add_u32 m0, s92, 25600
  s_nop 0
  buffer_load_dwordx4 v37, s[8:11], s61 offen lds
  s_add_u32 m0, s92, 26624
  s_nop 0
  buffer_load_dwordx4 v38, s[8:11], s61 offen lds
  s_add_u32 s71, s71, 1
  s_cmp_eq_u32 s71, 7
  s_cselect_b32 s71, 0, s71
  s_lshr_b32 s48, s45, 1
  s_and_b32 s49, s45, 1
  s_cmp_ge_u32 s37, 7
  s_cselect_b32 s46, 1, 0
  s_mul_i32 s63, s46, 7
  s_sub_u32 s47, s37, s63
  s_min_u32 s47, s47, 6
  s_getreg_b32 s40, hwreg(HW_REG_XCC_ID)
  s_and_b32 s40, s40, 7
  s_mov_b32 s50, 0
  s_mov_b32 s51, -1
  s_mov_b32 s52, -1
  s_mov_b32 s53, 0xffff
  s_mov_b32 s54, 0
  s_mov_b32 s55, 0xffff0000
  s_mov_b32 s41, 0
  s_mov_b32 s42, 0
  s_mov_b32 s43, 0
  s_lshl_b32 s72, s36, 2
  s_lshl_b32 s65, s46, 1
  s_add_u32 s72, s72, s65
  s_add_u32 s72, s72, s49
  s_mul_i32 s69, s72, 28672
  s_lshl_b32 s65, s47, 7
  s_add_u32 s69, s69, s65
  s_lshl_b32 s65, s48, 6
  s_add_u32 s69, s69, s65
  s_lshl_b32 s73, s36, 2
  s_add_u32 s73, s73, s45
  s_and_b32 s60, s36, 1
  s_lshl_b32 s88, s60, 2
  s_lshl_b32 s65, s46, 1
  s_add_u32 s88, s88, s65
  s_add_u32 s88, s88, s47
  v_mul_u32_u24 v25, 896, v2
  v_lshl_add_u32 v25, v3, 3, v25
  v_lshlrev_b32 v248, 7, v1
  v_lshrrev_b32 v18, 3, v1
  v_mul_u32_u24 v18, 896, v18
  v_bfe_u32 v19, v1, 4, 1
  v_lshlrev_b32 v19, 2, v19
  v_and_b32 v20, 7, v1
  v_xor_b32 v19, v19, v20
  v_lshl_add_u32 v240, v19, 4, v18
  s_lshl_b32 s60, s47, 7
  v_add_u32 v240, s60, v240
  s_mul_i32 s60, s37, 224
  v_add_u32 v18, 0, v1
  v_mul_u32_u24 v19, 4682, v18
  v_lshrrev_b32 v19, 16, v19
  v_mul_u32_u24 v19, 3360, v19
  v_lshl_add_u32 v241, v18, 4, v19
  v_add_u32 v241, s60, v241
  v_add_u32 v18, 64, v1
  v_mul_u32_u24 v19, 4682, v18
  v_lshrrev_b32 v19, 16, v19
  v_mul_u32_u24 v19, 3360, v19
  v_lshl_add_u32 v242, v18, 4, v19
  v_add_u32 v242, s60, v242
  v_add_u32 v18, 128, v1
  v_mul_u32_u24 v19, 4682, v18
  v_lshrrev_b32 v19, 16, v19
  v_mul_u32_u24 v19, 3360, v19
  v_lshl_add_u32 v243, v18, 4, v19
  v_add_u32 v243, s60, v243
  v_add_u32 v18, 192, v1
  v_mul_u32_u24 v19, 4682, v18
  v_lshrrev_b32 v19, 16, v19
  v_mul_u32_u24 v19, 3360, v19
  v_lshl_add_u32 v244, v18, 4, v19
  v_add_u32 v244, s60, v244
  v_add_u32 v18, 256, v1
  v_mul_u32_u24 v19, 4682, v18
  v_lshrrev_b32 v19, 16, v19
  v_mul_u32_u24 v19, 3360, v19
  v_lshl_add_u32 v245, v18, 4, v19
  v_add_u32 v245, s60, v245
  v_add_u32 v18, 320, v1
  v_mul_u32_u24 v19, 4682, v18
  v_lshrrev_b32 v19, 16, v19
  v_mul_u32_u24 v19, 3360, v19
  v_lshl_add_u32 v246, v18, 4, v19
  v_add_u32 v246, s60, v246
  v_add_u32 v18, 384, v1
  v_mul_u32_u24 v19, 4682, v18
  v_lshrrev_b32 v19, 16, v19
  v_mul_u32_u24 v19, 3360, v19
  v_lshl_add_u32 v247, v18, 4, v19
  v_add_u32 v247, s60, v247
  v_mov_b32 v48, 0
  v_mov_b32 v49, 0
  v_mov_b32 v50, 0
  v_mov_b32 v51, 0
  v_mov_b32 v52, 0
  v_mov_b32 v53, 0
  v_lshrrev_b32 v18, 2, v4
  v_lshl_add_u32 v18, v3, 3, v18
  v_mul_u32_u24 v54, 192, v18
  v_bfe_u32 v18, v1, 4, 1
  v_lshl_add_u32 v54, v18, 5, v54
  v_and_b32 v18, 3, v1
  v_lshl_add_u32 v54, v18, 3, v54
  v_add_u32 v54, s92, v54
  v_add_u32 v55, 61440, v54
  v_lshlrev_b32 v56, 4, v2
  v_mov_b32 v57, 0x3f803f80
  s_lshl_b32 s74, s73, 9
  s_add_u32 s74, s74, 18350080
  s_waitcnt vmcnt(10)
  s_barrier
  s_lshl_b32 s60, s70, 7
  s_add_u32 m0, s57, 118784
  s_nop 0
  buffer_load_dwordx4 v32, s[4:7], s60 offen lds
  s_add_u32 m0, s57, 119808
  s_nop 0
  buffer_load_dwordx4 v33, s[4:7], s60 offen lds
  s_add_u32 m0, s57, 120832
  s_nop 0
  buffer_load_dwordx4 v34, s[4:7], s60 offen lds
  s_add_u32 m0, s57, 121856
  s_nop 0
  buffer_load_dwordx4 v35, s[4:7], s60 offen lds
  s_add_u32 s70, s70, 1
  s_cmp_eq_u32 s70, 7
  s_cselect_b32 s70, 0, s70
  s_mul_i32 s61, s71, 172032
  s_add_u32 m0, s92, 36864
  s_nop 0
  buffer_load_dwordx4 v36, s[8:11], s61 offen lds
  s_add_u32 m0, s92, 37888
  s_nop 0
  buffer_load_dwordx4 v37, s[8:11], s61 offen lds
  s_add_u32 m0, s92, 38912
  s_nop 0
  buffer_load_dwordx4 v38, s[8:11], s61 offen lds
  s_add_u32 s71, s71, 1
  s_cmp_eq_u32 s71, 7
  s_cselect_b32 s71, 0, s71
  s_mul_i32 s61, s71, 172032
  s_add_u32 m0, s92, 49152
  s_nop 0
  buffer_load_dwordx4 v36, s[8:11], s61 offen lds
  s_add_u32 m0, s92, 50176
  s_nop 0
  buffer_load_dwordx4 v37, s[8:11], s61 offen lds
  s_add_u32 m0, s92, 51200
  s_nop 0
  buffer_load_dwordx4 v38, s[8:11], s61 offen lds
  s_add_u32 s71, s71, 1
  s_cmp_eq_u32 s71, 7
  s_cselect_b32 s71, 0, s71
  s_lshl_b32 s60, s70, 7
  s_add_u32 m0, s57, 135168
  s_nop 0
  buffer_load_dwordx4 v32, s[4:7], s60 offen lds
  s_add_u32 m0, s57, 136192
  s_nop 0
  buffer_load_dwordx4 v33, s[4:7], s60 offen lds
  s_add_u32 m0, s57, 137216
  s_nop 0
  buffer_load_dwordx4 v34, s[4:7], s60 offen lds
  s_add_u32 m0, s57, 138240
  s_nop 0
  buffer_load_dwordx4 v35, s[4:7], s60 offen lds
  s_add_u32 s70, s70, 1
  s_cmp_eq_u32 s70, 7
  s_cselect_b32 s70, 0, s70
  s_mul_i32 s61, s71, 172032
  s_add_u32 m0, s92, 61440
  s_nop 0
  buffer_load_dwordx4 v36, s[8:11], s61 offen lds
  s_add_u32 m0, s92, 62464
  s_nop 0
  buffer_load_dwordx4 v37, s[8:11], s61 offen lds
  s_add_u32 m0, s92, 63488
  s_nop 0
  buffer_load_dwordx4 v38, s[8:11], s61 offen lds
  s_add_u32 s71, s71, 1
  s_cmp_eq_u32 s71, 7
  s_cselect_b32 s71, 0, s71
  ds_read_b64_tr_b16 v[60:61], v54 offset:0
  ds_read_b64_tr_b16 v[62:63], v54 offset:768
  ds_read_b64_tr_b16 v[64:65], v54 offset:64
  ds_read_b64_tr_b16 v[66:67], v54 offset:832
  ds_read_b64_tr_b16 v[68:69], v54 offset:128
  ds_read_b64_tr_b16 v[70:71], v54 offset:896
  s_waitcnt lgkmcnt(0)
  v_dot2c_f32_bf16 v48, v60, v57
  v_dot2c_f32_bf16 v50, v64, v57
  v_dot2c_f32_bf16 v52, v68, v57
  v_dot2c_f32_bf16 v48, v61, v57
  v_dot2c_f32_bf16 v50, v65, v57
  v_dot2c_f32_bf16 v52, v69, v57
  v_dot2c_f32_bf16 v48, v62, v57
  v_dot2c_f32_bf16 v50, v66, v57
  v_dot2c_f32_bf16 v52, v70, v57
  v_dot2c_f32_bf16 v48, v63, v57
  v_dot2c_f32_bf16 v50, v67, v57
  v_dot2c_f32_bf16 v52, v71, v57
  s_waitcnt vmcnt(17)
  s_barrier
  s_lshl_b32 s60, s70, 7
  s_add_u32 m0, s57, 86016
  s_nop 0
  buffer_load_dwordx4 v32, s[4:7], s60 offen lds
  s_add_u32 m0, s57, 87040
  s_nop 0
  buffer_load_dwordx4 v33, s[4:7], s60 offen lds
  s_add_u32 m0, s57, 88064
  s_nop 0
  buffer_load_dwordx4 v34, s[4:7], s60 offen lds
  s_add_u32 m0, s57, 89088
  s_nop 0
  buffer_load_dwordx4 v35, s[4:7], s60 offen lds
  s_add_u32 s70, s70, 1
  s_cmp_eq_u32 s70, 7
  s_cselect_b32 s70, 0, s70
  s_mul_i32 s61, s71, 172032
  s_add_u32 m0, s92, 73728
  s_nop 0
  buffer_load_dwordx4 v36, s[8:11], s61 offen lds
  s_add_u32 m0, s92, 74752
  s_nop 0
  buffer_load_dwordx4 v37, s[8:11], s61 offen lds
  s_add_u32 m0, s92, 75776
  s_nop 0
  buffer_load_dwordx4 v38, s[8:11], s61 offen lds
  s_add_u32 s71, s71, 1
  s_cmp_eq_u32 s71, 7
  s_cselect_b32 s71, 0, s71
  ds_read_b64_tr_b16 v[60:61], v54 offset:12288
  ds_read_b64_tr_b16 v[62:63], v54 offset:13056
  ds_read_b64_tr_b16 v[64:65], v54 offset:12352
  ds_read_b64_tr_b16 v[66:67], v54 offset:13120
  ds_read_b64_tr_b16 v[68:69], v54 offset:12416
  ds_read_b64_tr_b16 v[70:71], v54 offset:13184
  s_waitcnt lgkmcnt(0)
  v_dot2c_f32_bf16 v48, v60, v57
  v_dot2c_f32_bf16 v50, v64, v57
  v_dot2c_f32_bf16 v52, v68, v57
  v_dot2c_f32_bf16 v48, v61, v57
  v_dot2c_f32_bf16 v50, v65, v57
  v_dot2c_f32_bf16 v52, v69, v57
  v_dot2c_f32_bf16 v48, v62, v57
  v_dot2c_f32_bf16 v50, v66, v57
  v_dot2c_f32_bf16 v52, v70, v57
  v_dot2c_f32_bf16 v48, v63, v57
  v_dot2c_f32_bf16 v50, v67, v57
  v_dot2c_f32_bf16 v52, v71, v57
  ds_read_b64_tr_b16 v[60:61], v54 offset:24576
  ds_read_b64_tr_b16 v[62:63], v54 offset:25344
  ds_read_b64_tr_b16 v[64:65], v54 offset:24640
  ds_read_b64_tr_b16 v[66:67], v54 offset:25408
  ds_read_b64_tr_b16 v[68:69], v54 offset:24704
  ds_read_b64_tr_b16 v[70:71], v54 offset:25472
  s_waitcnt lgkmcnt(0)
  v_dot2c_f32_bf16 v48, v60, v57
  v_dot2c_f32_bf16 v50, v64, v57
  v_dot2c_f32_bf16 v52, v68, v57
  v_dot2c_f32_bf16 v48, v61, v57
  v_dot2c_f32_bf16 v50, v65, v57
  v_dot2c_f32_bf16 v52, v69, v57
  v_dot2c_f32_bf16 v48, v62, v57
  v_dot2c_f32_bf16 v50, v66, v57
  v_dot2c_f32_bf16 v52, v70, v57
  v_dot2c_f32_bf16 v48, v63, v57
  v_dot2c_f32_bf16 v50, v67, v57
  v_dot2c_f32_bf16 v52, v71, v57
  s_waitcnt vmcnt(14)
  s_barrier
  s_lshl_b32 s60, s70, 7
  s_add_u32 m0, s57, 102400
  s_nop 0
  buffer_load_dwordx4 v32, s[4:7], s60 offen lds
  s_add_u32 m0, s57, 103424
  s_nop 0
  buffer_load_dwordx4 v33, s[4:7], s60 offen lds
  s_add_u32 m0, s57, 104448
  s_nop 0
  buffer_load_dwordx4 v34, s[4:7], s60 offen lds
  s_add_u32 m0, s57, 105472
  s_nop 0
  buffer_load_dwordx4 v35, s[4:7], s60 offen lds
  s_add_u32 s70, s70, 1
  s_cmp_eq_u32 s70, 7
  s_cselect_b32 s70, 0, s70
  ds_read_b64_tr_b16 v[60:61], v54 offset:36864
  ds_read_b64_tr_b16 v[62:63], v54 offset:37632
  ds_read_b64_tr_b16 v[64:65], v54 offset:36928
  ds_read_b64_tr_b16 v[66:67], v54 offset:37696
  ds_read_b64_tr_b16 v[68:69], v54 offset:36992
  ds_read_b64_tr_b16 v[70:71], v54 offset:37760
  s_waitcnt lgkmcnt(0)
  v_dot2c_f32_bf16 v48, v60, v57
  v_dot2c_f32_bf16 v50, v64, v57
  v_dot2c_f32_bf16 v52, v68, v57
  v_dot2c_f32_bf16 v48, v61, v57
  v_dot2c_f32_bf16 v50, v65, v57
  v_dot2c_f32_bf16 v52, v69, v57
  v_dot2c_f32_bf16 v48, v62, v57
  v_dot2c_f32_bf16 v50, v66, v57
  v_dot2c_f32_bf16 v52, v70, v57
  v_dot2c_f32_bf16 v48, v63, v57
  v_dot2c_f32_bf16 v50, v67, v57
  v_dot2c_f32_bf16 v52, v71, v57
  ds_read_b64_tr_b16 v[60:61], v54 offset:49152
  ds_read_b64_tr_b16 v[62:63], v54 offset:49920
  ds_read_b64_tr_b16 v[64:65], v54 offset:49216
  ds_read_b64_tr_b16 v[66:67], v54 offset:49984
  ds_read_b64_tr_b16 v[68:69], v54 offset:49280
  ds_read_b64_tr_b16 v[70:71], v54 offset:50048
  s_waitcnt lgkmcnt(0)
  v_dot2c_f32_bf16 v48, v60, v57
  v_dot2c_f32_bf16 v50, v64, v57
  v_dot2c_f32_bf16 v52, v68, v57
  v_dot2c_f32_bf16 v48, v61, v57
  v_dot2c_f32_bf16 v50, v65, v57
  v_dot2c_f32_bf16 v52, v69, v57
  v_dot2c_f32_bf16 v48, v62, v57
  v_dot2c_f32_bf16 v50, v66, v57
  v_dot2c_f32_bf16 v52, v70, v57
  v_dot2c_f32_bf16 v48, v63, v57
  v_dot2c_f32_bf16 v50, v67, v57
  v_dot2c_f32_bf16 v52, v71, v57
  s_waitcnt vmcnt(11)
  s_barrier
  s_lshl_b32 s60, s70, 7
  s_add_u32 m0, s57, 118784
  s_nop 0
  buffer_load_dwordx4 v32, s[4:7], s60 offen lds
  s_add_u32 m0, s57, 119808
  s_nop 0
  buffer_load_dwordx4 v33, s[4:7], s60 offen lds
  s_add_u32 m0, s57, 120832
  s_nop 0
  buffer_load_dwordx4 v34, s[4:7], s60 offen lds
  s_add_u32 m0, s57, 121856
  s_nop 0
  buffer_load_dwordx4 v35, s[4:7], s60 offen lds
  s_add_u32 s70, s70, 1
  s_cmp_eq_u32 s70, 7
  s_cselect_b32 s70, 0, s70
  buffer_load_dwordx4 v[76:79], v56, s[32:35], s74 offen sc1
  ds_read_b64_tr_b16 v[60:61], v55 offset:0
  ds_read_b64_tr_b16 v[62:63], v55 offset:768
  ds_read_b64_tr_b16 v[64:65], v55 offset:64
  ds_read_b64_tr_b16 v[66:67], v55 offset:832
  ds_read_b64_tr_b16 v[68:69], v55 offset:128
  ds_read_b64_tr_b16 v[70:71], v55 offset:896
  s_waitcnt lgkmcnt(0)
  v_dot2c_f32_bf16 v48, v60, v57
  v_dot2c_f32_bf16 v50, v64, v57
  v_dot2c_f32_bf16 v52, v68, v57
  v_dot2c_f32_bf16 v48, v61, v57
  v_dot2c_f32_bf16 v50, v65, v57
  v_dot2c_f32_bf16 v52, v69, v57
  v_dot2c_f32_bf16 v48, v62, v57
  v_dot2c_f32_bf16 v50, v66, v57
  v_dot2c_f32_bf16 v52, v70, v57
  v_dot2c_f32_bf16 v48, v63, v57
  v_dot2c_f32_bf16 v50, v67, v57
  v_dot2c_f32_bf16 v52, v71, v57
  s_waitcnt vmcnt(9)
  s_barrier
  ds_read_b64_tr_b16 v[60:61], v55 offset:12288
  ds_read_b64_tr_b16 v[62:63], v55 offset:13056
  ds_read_b64_tr_b16 v[64:65], v55 offset:12352
  ds_read_b64_tr_b16 v[66:67], v55 offset:13120
  ds_read_b64_tr_b16 v[68:69], v55 offset:12416
  ds_read_b64_tr_b16 v[70:71], v55 offset:13184
  s_waitcnt lgkmcnt(0)
  v_dot2c_f32_bf16 v48, v60, v57
  v_dot2c_f32_bf16 v50, v64, v57
  v_dot2c_f32_bf16 v52, v68, v57
  v_dot2c_f32_bf16 v48, v61, v57
  v_dot2c_f32_bf16 v50, v65, v57
  v_dot2c_f32_bf16 v52, v69, v57
  v_dot2c_f32_bf16 v48, v62, v57
  v_dot2c_f32_bf16 v50, v66, v57
  v_dot2c_f32_bf16 v52, v70, v57
  v_dot2c_f32_bf16 v48, v63, v57
  v_dot2c_f32_bf16 v50, v67, v57
  v_dot2c_f32_bf16 v52, v71, v57
  s_nop 0
  v_add_f32 v48, v48, v49
  v_mov_b32 v18, v48
  s_nop 1
  v_permlane32_swap_b32 v48, v18
  v_add_f32 v48, v48, v18
  v_add_f32 v50, v50, v51
  v_mov_b32 v18, v50
  s_nop 1
  v_permlane32_swap_b32 v50, v18
  v_add_f32 v50, v50, v18
  v_add_f32 v52, v52, v53
  v_mov_b32 v18, v52
  s_nop 1
  v_permlane32_swap_b32 v52, v18
  v_add_f32 v52, v52, v18
  s_mul_i32 s60, s45, 384
  s_add_u32 s60, s60, 158720
  v_lshl_add_u32 v18, v2, 2, s60
  ds_write_b32 v18, v48 offset:0
  ds_write_b32 v18, v50 offset:128
  ds_write_b32 v18, v52 offset:256
  s_waitcnt lgkmcnt(0)
  s_waitcnt vmcnt(5)
  s_barrier
  s_min_u32 s60, s45, 2
  s_lshl_b32 s60, s60, 7
  s_add_u32 s61, s60, 158720
  v_lshl_add_u32 v22, v2, 2, s61
  s_add_u32 s61, s60, 160768
  v_lshl_add_u32 v23, v2, 2, s61
  ds_read_b32 v60, v22 offset:0
  ds_read_b32 v61, v22 offset:384
  ds_read_b32 v62, v22 offset:768
  ds_read_b32 v63, v22 offset:1152
  s_waitcnt lgkmcnt(0)
  v_add_f32 v60, v60, v61
  v_add_f32 v62, v62, v63
  v_add_f32 v60, v60, v62
  ds_write_b32 v23, v60
  v_mov_b32 v18, 162176
  ds_read_b64 v[16:17], v18
  s_waitcnt lgkmcnt(0)
  v_readfirstlane_b32 s42, v16
  v_readfirstlane_b32 s43, v17
  v_or_b32 v16, s40, v16
  s_mov_b32 s58, 0x20000
  s_waitcnt vmcnt(0)
  s_nop 1
Lst_loop:
  v_cmp_ne_u32 vcc, s42, v77
  v_cmp_ne_u32 s[94:95], s43, v79
  s_nop 1
  s_or_b64 vcc, vcc, s[94:95]
  s_nop 1
  s_cbranch_scc0 Lst_ok
  buffer_load_dwordx4 v[76:79], v56, s[32:35], s74 offen sc1
  s_sub_u32 s58, s58, 1
  s_waitcnt vmcnt(0)
  s_cmp_lg_u32 s58, 0
  s_cbranch_scc1 Lst_loop
Lst_ok:
  s_lshl_b32 s60, s45, 8
  s_add_u32 s60, s60, 161152
  v_lshl_add_u32 v18, v2, 2, s60
  ds_write_b32 v18, v76
  ds_write_b32 v18, v78 offset:128
  s_waitcnt lgkmcnt(0)
  s_barrier
  s_barrier
  s_mul_i32 s60, s45, 7168
  s_add_u32 m0, s56, 86016
  s_nop 0
  buffer_load_dwordx4 v240, s[12:15], s60 offen lds
  s_add_u32 s60, s60, 28672
  s_add_u32 m0, s56, 90112
  s_nop 0
  buffer_load_dwordx4 v240, s[12:15], s60 offen lds
  s_add_u32 s60, s60, 28672
  s_add_u32 m0, s56, 94208
  s_nop 0
  buffer_load_dwordx4 v240, s[12:15], s60 offen lds
  s_add_u32 s60, s60, 28672
  s_add_u32 m0, s56, 98304
  s_nop 0
  buffer_load_dwordx4 v240, s[12:15], s60 offen lds
  s_add_u32 s60, s60, 28672
  s_add_u32 m0, s56, 102400
  s_nop 0
  buffer_load_dwordx4 v240, s[12:15], s60 offen lds
  s_add_u32 s60, s60, 28672
  s_add_u32 m0, s56, 106496
  s_nop 0
  buffer_load_dwordx4 v240, s[12:15], s60 offen lds
  s_add_u32 s60, s60, 28672
  s_add_u32 m0, s56, 110592
  s_nop 0
  buffer_load_dwordx4 v240, s[12:15], s60 offen lds
  s_add_u32 s60, s60, 28672
  s_add_u32 m0, s56, 114688
  s_nop 0
  buffer_load_dwordx4 v240, s[12:15], s60 offen lds
  s_add_u32 s60, s60, 28672
  s_add_u32 m0, s56, 118784
  s_nop 0
  buffer_load_dwordx4 v240, s[12:15], s60 offen lds
  s_add_u32 s60, s60, 28672
  s_add_u32 m0, s56, 122880
  s_nop 0
  buffer_load_dwordx4 v240, s[12:15], s60 offen lds
  s_add_u32 s60, s60, 28672
  s_add_u32 m0, s56, 126976
  s_nop 0
  buffer_load_dwordx4 v240, s[12:15], s60 offen lds
  s_add_u32 s60, s60, 28672
  s_add_u32 m0, s56, 131072
  s_nop 0
  buffer_load_dwordx4 v240, s[12:15], s60 offen lds
  s_add_u32 s60, s60, 28672
  s_add_u32 m0, s56, 135168
  s_nop 0
  buffer_load_dwordx4 v240, s[12:15], s60 offen lds
  s_add_u32 s60, s60, 28672
  s_add_u32 m0, s56, 139264
  s_nop 0
  buffer_load_dwordx4 v240, s[12:15], s60 offen lds
  s_add_u32 s60, s60, 28672
  s_mov_b32 s60, 401408
  s_mov_b32 m0, 143360
  s_nop 0
  buffer_load_dwordx4 v240, s[12:15], s60 offen lds
  s_branch Lp2
Lservice:
  s_sub_u32 s60, s37, 14
  s_lshl_b32 s61, s60, 6
  s_lshl_b32 s65, s38, 3
  s_add_u32 s61, s61, s65
  s_add_u32 s61, s61, s39
  s_mul_i32 s62, s61, 896
  v_lshrrev_b32 v18, 3, v1
  v_mul_u32_u24 v40, 896, v18
  v_and_b32 v19, 7, v1
  v_lshl_add_u32 v40, v19, 4, v40
  buffer_load_dwordx4 v[44:47], v40, s[4:7], s62 offen offset:0
  buffer_load_dwordx4 v[48:51], v40, s[4:7], s62 offen offset:128
  buffer_load_dwordx4 v[52:55], v40, s[4:7], s62 offen offset:256
  buffer_load_dwordx4 v[56:59], v40, s[4:7], s62 offen offset:384
  buffer_load_dwordx4 v[60:63], v40, s[4:7], s62 offen offset:512
  buffer_load_dwordx4 v[64:67], v40, s[4:7], s62 offen offset:640
  buffer_load_dwordx4 v[68:71], v40, s[4:7], s62 offen offset:768
  buffer_load_dwordx2 v[16:17], v24, s[28:31], 0 offen sc1
  s_lshl_b32 s74, s61, 4
  s_add_u32 s74, s74, 18350080
  v_lshlrev_b32 v41, 4, v18
  s_lshr_b32 s48, s45, 1
  s_and_b32 s49, s45, 1
  s_cmp_ge_u32 s37, 7
  s_cselect_b32 s46, 1, 0
  s_mul_i32 s63, s46, 7
  s_sub_u32 s47, s37, s63
  s_min_u32 s47, s47, 6
  s_getreg_b32 s40, hwreg(HW_REG_XCC_ID)
  s_and_b32 s40, s40, 7
  s_mov_b32 s50, 0
  s_mov_b32 s51, -1
  s_mov_b32 s52, -1
  s_mov_b32 s53, 0xffff
  s_mov_b32 s54, 0
  s_mov_b32 s55, 0xffff0000
  s_mov_b32 s41, 0
  s_mov_b32 s42, 0
  s_mov_b32 s43, 0
  s_lshl_b32 s72, s36, 2
  s_lshl_b32 s65, s46, 1
  s_add_u32 s72, s72, s65
  s_add_u32 s72, s72, s49
  s_mul_i32 s69, s72, 28672
  s_lshl_b32 s65, s47, 7
  s_add_u32 s69, s69, s65
  s_lshl_b32 s65, s48, 6
  s_add_u32 s69, s69, s65
  s_lshl_b32 s73, s36, 2
  s_add_u32 s73, s73, s45
  s_and_b32 s60, s36, 1
  s_lshl_b32 s88, s60, 2
  s_lshl_b32 s65, s46, 1
  s_add_u32 s88, s88, s65
  s_add_u32 s88, s88, s47
  v_mul_u32_u24 v25, 896, v2
  v_lshl_add_u32 v25, v3, 3, v25
  v_lshlrev_b32 v248, 7, v1
  v_lshrrev_b32 v18, 3, v1
  v_mul_u32_u24 v18, 896, v18
  v_bfe_u32 v19, v1, 4, 1
  v_lshlrev_b32 v19, 2, v19
  v_and_b32 v20, 7, v1
  v_xor_b32 v19, v19, v20
  v_lshl_add_u32 v240, v19, 4, v18
  s_lshl_b32 s60, s47, 7
  v_add_u32 v240, s60, v240
  s_mul_i32 s60, s37, 224
  v_add_u32 v18, 0, v1
  v_mul_u32_u24 v19, 4682, v18
  v_lshrrev_b32 v19, 16, v19
  v_mul_u32_u24 v19, 3360, v19
  v_lshl_add_u32 v241, v18, 4, v19
  v_add_u32 v241, s60, v241
  v_add_u32 v18, 64, v1
  v_mul_u32_u24 v19, 4682, v18
  v_lshrrev_b32 v19, 16, v19
  v_mul_u32_u24 v19, 3360, v19
  v_lshl_add_u32 v242, v18, 4, v19
  v_add_u32 v242, s60, v242
  v_add_u32 v18, 128, v1
  v_mul_u32_u24 v19, 4682, v18
  v_lshrrev_b32 v19, 16, v19
  v_mul_u32_u24 v19, 3360, v19
  v_lshl_add_u32 v243, v18, 4, v19
  v_add_u32 v243, s60, v243
  v_add_u32 v18, 192, v1
  v_mul_u32_u24 v19, 4682, v18
  v_lshrrev_b32 v19, 16, v19
  v_mul_u32_u24 v19, 3360, v19
  v_lshl_add_u32 v244, v18, 4, v19
  v_add_u32 v244, s60, v244
  v_add_u32 v18, 256, v1
  v_mul_u32_u24 v19, 4682, v18
  v_lshrrev_b32 v19, 16, v19
  v_mul_u32_u24 v19, 3360, v19
  v_lshl_add_u32 v245, v18, 4, v19
  v_add_u32 v245, s60, v245
  v_add_u32 v18, 320, v1
  v_mul_u32_u24 v19, 4682, v18
  v_lshrrev_b32 v19, 16, v19
  v_mul_u32_u24 v19, 3360, v19
  v_lshl_add_u32 v246, v18, 4, v19
  v_add_u32 v246, s60, v246
  v_add_u32 v18, 384, v1
  v_mul_u32_u24 v19, 4682, v18
  v_lshrrev_b32 v19, 16, v19
  v_mul_u32_u24 v19, 3360, v19
  v_lshl_add_u32 v247, v18, 4, v19
  v_add_u32 v247, s60, v247
  v_mov_b32 v42, 0
  v_mov_b32 v43, 0
  v_mov_b32 v39, 0x3f803f80
  s_waitcnt vmcnt(1)
  v_dot2c_f32_bf16 v42, v44, v39
  v_dot2c_f32_bf16 v43, v44, v44
  v_dot2c_f32_bf16 v42, v45, v39
  v_dot2c_f32_bf16 v43, v45, v45
  v_dot2c_f32_bf16 v42, v46, v39
  v_dot2c_f32_bf16 v43, v46, v46
  v_dot2c_f32_bf16 v42, v47, v39
  v_dot2c_f32_bf16 v43, v47, v47
  v_dot2c_f32_bf16 v42, v48, v39
  v_dot2c_f32_bf16 v43, v48, v48
  v_dot2c_f32_bf16 v42, v49, v39
  v_dot2c_f32_bf16 v43, v49, v49
  v_dot2c_f32_bf16 v42, v50, v39
  v_dot2c_f32_bf16 v43, v50, v50
  v_dot2c_f32_bf16 v42, v51, v39
  v_dot2c_f32_bf16 v43, v51, v51
  v_dot2c_f32_bf16 v42, v52, v39
  v_dot2c_f32_bf16 v43, v52, v52
  v_dot2c_f32_bf16 v42, v53, v39
  v_dot2c_f32_bf16 v43, v53, v53
  v_dot2c_f32_bf16 v42, v54, v39
  v_dot2c_f32_bf16 v43, v54, v54
  v_dot2c_f32_bf16 v42, v55, v39
  v_dot2c_f32_bf16 v43, v55, v55
  v_dot2c_f32_bf16 v42, v56, v39
  v_dot2c_f32_bf16 v43, v56, v56
  v_dot2c_f32_bf16 v42, v57, v39
  v_dot2c_f32_bf16 v43, v57, v57
  v_dot2c_f32_bf16 v42, v58, v39
  v_dot2c_f32_bf16 v43, v58, v58
  v_dot2c_f32_bf16 v42, v59, v39
  v_dot2c_f32_bf16 v43, v59, v59
  v_dot2c_f32_bf16 v42, v60, v39
  v_dot2c_f32_bf16 v43, v60, v60
  v_dot2c_f32_bf16 v42, v61, v39
  v_dot2c_f32_bf16 v43, v61, v61
  v_dot2c_f32_bf16 v42, v62, v39
  v_dot2c_f32_bf16 v43, v62, v62
  v_dot2c_f32_bf16 v42, v63, v39
  v_dot2c_f32_bf16 v43, v63, v63
  v_dot2c_f32_bf16 v42, v64, v39
  v_dot2c_f32_bf16 v43, v64, v64
  v_dot2c_f32_bf16 v42, v65, v39
  v_dot2c_f32_bf16 v43, v65, v65
  v_dot2c_f32_bf16 v42, v66, v39
  v_dot2c_f32_bf16 v43, v66, v66
  v_dot2c_f32_bf16 v42, v67, v39
  v_dot2c_f32_bf16 v43, v67, v67
  v_dot2c_f32_bf16 v42, v68, v39
  v_dot2c_f32_bf16 v43, v68, v68
  v_dot2c_f32_bf16 v42, v69, v39
  v_dot2c_f32_bf16 v43, v69, v69
  v_dot2c_f32_bf16 v42, v70, v39
  v_dot2c_f32_bf16 v43, v70, v70
  v_dot2c_f32_bf16 v42, v71, v39
  v_dot2c_f32_bf16 v43, v71, v71
  s_nop 1
  ds_swizzle_b32 v20, v42 offset:0x41f
  ds_swizzle_b32 v21, v43 offset:0x41f
  s_waitcnt lgkmcnt(0)
  v_add_f32 v42, v42, v20
  v_add_f32 v43, v43, v21
  ds_swizzle_b32 v20, v42 offset:0x81f
  ds_swizzle_b32 v21, v43 offset:0x81f
  s_waitcnt lgkmcnt(0)
  v_add_f32 v42, v42, v20
  v_add_f32 v43, v43, v21
  ds_swizzle_b32 v20, v42 offset:0x101f
  ds_swizzle_b32 v21, v43 offset:0x101f
  s_waitcnt lgkmcnt(0)
  v_add_f32 v42, v42, v20
  v_add_f32 v43, v43, v21
  v_mul_f32 v42, 0x3b124925, v42
  v_mul_f32 v43, 0x3b124925, v43
  v_fma_f32 v43, -v42, v42, v43
  v_max_f32 v43, 0, v43
  v_cvt_pk_bf16_f32 v43, v43, v43
  v_and_b32 v43, 0xffff0000, v43
  v_add_f32 v43, 0x3727c5ac, v43
  v_cvt_pk_bf16_f32 v43, v43, v43
  v_and_b32 v43, 0xffff0000, v43
  v_sqrt_f32 v43, v43
  s_nop 0
  v_cvt_pk_bf16_f32 v43, v43, v43
  v_and_b32 v43, 0xffff0000, v43
  v_rcp_f32 v46, v43
  v_cvt_pk_bf16_f32 v20, v42, v42
  v_and_b32 v20, 0xffff0000, v20
  v_sub_f32 v44, 0, v20
  s_mov_b32 s58, 0x20000
  s_nop 1
Lep_svc:
  s_waitcnt vmcnt(0)
  v_readfirstlane_b32 s42, v16
  v_readfirstlane_b32 s43, v17
  s_nop 0
  s_cmp_lg_u32 s42, 0
  s_nop 2
  s_cbranch_scc1 Lepd_svc
  s_sleep 4
  buffer_load_dwordx2 v[16:17], v24, s[28:31], 0 offen sc1
  s_sub_u32 s58, s58, 1
  s_cmp_lg_u32 s58, 0
  s_cbranch_scc1 Lep_svc
Lepd_svc:
  v_mov_b32 v45, s42
  v_mov_b32 v47, s43
  v_or_b32 v16, s40, v16
  buffer_store_dwordx4 v[44:47], v41, s[32:35], s74 offen sc1
  s_lshl_b32 s60, s36, 9
  s_lshl_b32 s65, s37, 3
  s_add_u32 s60, s60, s65
  s_add_u32 s60, s60, 17825792
  s_mov_b64 exec, 1
  buffer_store_dwordx2 v[16:17], v24, s[32:35], s60 offen sc1
  s_mov_b64 exec, -1
  s_waitcnt vmcnt(0)
  s_barrier
  s_sub_u32 s60, s37, 14
  s_lshl_b32 s64, s60, 3
  s_add_u32 s64, s64, s38
  s_lshl_b32 s61, s36, 17
  s_lshl_b32 s65, s64, 13
  s_add_u32 s61, s61, s65
  s_add_u32 s61, s61, 6291456
  buffer_load_dword v26, v248, s[32:35], s61 offen sc1
  s_lshl_b32 s61, s36, 14
  s_lshl_b32 s65, s64, 10
  s_add_u32 s61, s61, s65
  s_add_u32 s61, s61, 18087936
  v_min_u32 v18, 896, v248
  buffer_load_dword v26, v18, s[32:35], s61 offen sc1
  s_lshl_b32 s61, s36, 10
  s_add_u32 s61, s61, 17891328
  v_min_u32 v18, 896, v248
  buffer_load_dword v26, v18, s[32:35], s61 offen sc1
  s_lshl_b32 s61, s36, 9
  s_add_u32 s61, s61, 17956864
  v_min_u32 v18, 384, v248
  buffer_load_dword v26, v18, s[32:35], s61 offen sc1
  s_lshl_b32 s61, s36, 9
  s_add_u32 s61, s61, 18022400
  v_min_u32 v18, 384, v248
  buffer_load_dword v26, v18, s[32:35], s61 offen sc1
  s_and_b32 s60, s36, 1
  s_lshl_b32 s63, s60, 4
  s_add_u32 s63, s63, s64
  s_mul_i32 s61, s63, 12544
  buffer_load_dword v26, v248, s[12:15], s61 offen
  s_add_u32 s61, s61, 8192
  v_min_u32 v18, 4224, v248
  buffer_load_dword v26, v18, s[12:15], s61 offen
  v_lshrrev_b32 v18, 3, v1
  v_min_u32 v18, 2, v18
  v_bfe_u32 v19, v1, 1, 2
  v_min_u32 v19, 2, v19
  v_cmp_gt_u32 vcc, 2, v18
  v_max_u32 v20, 1, v19
  s_nop 0
  v_cndmask_b32 v19, v19, v20, vcc
  v_mul_u32_u24 v19, 448, v19
  v_and_b32 v20, 1, v1
  v_mul_u32_u24 v20, 31, v20
  s_mul_i32 s60, s37, 7
  s_lshr_b32 s78, s60, 1
  s_lshl_b32 s60, s78, 3
  v_add3_u32 v19, v19, v20, s60
  v_mul_u32_u24 v19, 2731, v19
  v_lshrrev_b32 v19, 18, v19
  v_min_u32 v19, 13, v19
  v_add_u32 v20, s36, v18
  v_cmp_gt_u32 vcc, 2, v20
  v_subrev_u32 v20, 2, v20
  v_mov_b32 v21, s36
  v_cndmask_b32 v20, v20, v21, vcc
  v_lshlrev_b32 v20, 9, v20
  v_lshl_add_u32 v20, v19, 3, v20
  s_lshl_b32 s60, s45, 7
  s_add_u32 s60, s60, 17825792
  v_add_u32 v27, s60, v20
  s_mul_i32 s86, s73, 86016
  s_lshl_b32 s65, s78, 9
  s_add_u32 s86, s86, s65
  s_sub_u32 s85, s86, 344064
  s_sub_u32 s84, s86, 688128
  s_cmp_lt_u32 s36, 1
  s_cselect_b32 s85, 0x40000000, s85
  s_cmp_lt_u32 s36, 2
  s_cselect_b32 s84, 0x40000000, s84
  s_lshl_b32 s87, s45, 11
  s_cmp_lt_u32 s38, 4
  s_cbranch_scc1 Lfetch
  s_branch Lp2
Lmfma:
  s_lshr_b32 s48, s45, 1
  s_and_b32 s49, s45, 1
  s_cmp_ge_u32 s37, 7
  s_cselect_b32 s46, 1, 0
  s_mul_i32 s63, s46, 7
  s_sub_u32 s47, s37, s63
  s_min_u32 s47, s47, 6
  s_getreg_b32 s40, hwreg(HW_REG_XCC_ID)
  s_and_b32 s40, s40, 7
  s_mov_b32 s50, 0
  s_mov_b32 s51, -1
  s_mov_b32 s52, -1
  s_mov_b32 s53, 0xffff
  s_mov_b32 s54, 0
  s_mov_b32 s55, 0xffff0000
  s_mov_b32 s41, 0
  s_mov_b32 s42, 0
  s_mov_b32 s43, 0
  s_lshl_b32 s72, s36, 2
  s_lshl_b32 s65, s46, 1
  s_add_u32 s72, s72, s65
  s_add_u32 s72, s72, s49
  s_mul_i32 s69, s72, 28672
  s_lshl_b32 s65, s47, 7
  s_add_u32 s69, s69, s65
  s_lshl_b32 s65, s48, 6
  s_add_u32 s69, s69, s65
  s_lshl_b32 s73, s36, 2
  s_add_u32 s73, s73, s45
  s_and_b32 s60, s36, 1
  s_lshl_b32 s88, s60, 2
  s_lshl_b32 s65, s46, 1
  s_add_u32 s88, s88, s65
  s_add_u32 s88, s88, s47
  v_mul_u32_u24 v25, 896, v2
  v_lshl_add_u32 v25, v3, 3, v25
  v_lshlrev_b32 v248, 7, v1
  v_lshrrev_b32 v18, 3, v1
  v_mul_u32_u24 v18, 896, v18
  v_bfe_u32 v19, v1, 4, 1
  v_lshlrev_b32 v19, 2, v19
  v_and_b32 v20, 7, v1
  v_xor_b32 v19, v19, v20
  v_lshl_add_u32 v240, v19, 4, v18
  s_lshl_b32 s60, s47, 7
  v_add_u32 v240, s60, v240
  s_mul_i32 s60, s37, 224
  v_add_u32 v18, 0, v1
  v_mul_u32_u24 v19, 4682, v18
  v_lshrrev_b32 v19, 16, v19
  v_mul_u32_u24 v19, 3360, v19
  v_lshl_add_u32 v241, v18, 4, v19
  v_add_u32 v241, s60, v241
  v_add_u32 v18, 64, v1
  v_mul_u32_u24 v19, 4682, v18
  v_lshrrev_b32 v19, 16, v19
  v_mul_u32_u24 v19, 3360, v19
  v_lshl_add_u32 v242, v18, 4, v19
  v_add_u32 v242, s60, v242
  v_add_u32 v18, 128, v1
  v_mul_u32_u24 v19, 4682, v18
  v_lshrrev_b32 v19, 16, v19
  v_mul_u32_u24 v19, 3360, v19
  v_lshl_add_u32 v243, v18, 4, v19
  v_add_u32 v243, s60, v243
  v_add_u32 v18, 192, v1
  v_mul_u32_u24 v19, 4682, v18
  v_lshrrev_b32 v19, 16, v19
  v_mul_u32_u24 v19, 3360, v19
  v_lshl_add_u32 v244, v18, 4, v19
  v_add_u32 v244, s60, v244
  v_add_u32 v18, 256, v1
  v_mul_u32_u24 v19, 4682, v18
  v_lshrrev_b32 v19, 16, v19
  v_mul_u32_u24 v19, 3360, v19
  v_lshl_add_u32 v245, v18, 4, v19
  v_add_u32 v245, s60, v245
  v_add_u32 v18, 320, v1
  v_mul_u32_u24 v19, 4682, v18
  v_lshrrev_b32 v19, 16, v19
  v_mul_u32_u24 v19, 3360, v19
  v_lshl_add_u32 v246, v18, 4, v19
  v_add_u32 v246, s60, v246
  v_add_u32 v18, 384, v1
  v_mul_u32_u24 v19, 4682, v18
  v_lshrrev_b32 v19, 16, v19
  v_mul_u32_u24 v19, 3360, v19
  v_lshl_add_u32 v247, v18, 4, v19
  v_add_u32 v247, s60, v247
  v_bfe_u32 v18, v2, 1, 3
  v_xor_b32 v18, v18, v3
  v_lshlrev_b32 v19, 7, v2
  v_add_u32 v19, s57, v19
  v_add_u32 v19, 86016, v19
  v_xor_b32 v20, 0, v18
  v_lshl_add_u32 v148, v20, 4, v19
  v_xor_b32 v20, 2, v18
  v_lshl_add_u32 v149, v20, 4, v19
  v_xor_b32 v20, 4, v18
  v_lshl_add_u32 v150, v20, 4, v19
  v_xor_b32 v20, 6, v18
  v_lshl_add_u32 v151, v20, 4, v19
  v_lshrrev_b32 v18, 2, v4
  v_lshl_add_u32 v18, v3, 3, v18
  v_mul_u32_u24 v152, 192, v18
  v_bfe_u32 v18, v1, 4, 1
  v_lshl_add_u32 v152, v18, 5, v152
  v_and_b32 v18, 3, v1
  v_lshl_add_u32 v152, v18, 3, v152
  v_add_u32 v153, 61440, v152
  s_lshl_b32 s60, s45, 8
  s_add_u32 s60, s60, 161152
  v_lshl_add_u32 v154, v2, 2, s60
  v_lshlrev_b32 v155, 4, v3
  v_add_u32 v155, 160768, v155
  v_mul_u32_u24 v18, 12, v3
  v_xor_b32 v18, v18, v1
  v_lshlrev_b32 v156, 4, v18
  s_mul_i32 s74, s73, 86016
  s_mul_i32 s65, s37, 6144
  s_add_u32 s74, s74, s65
  s_add_u32 s76, s74, 4096
  s_lshl_b32 s77, s73, 7
  s_lshl_b32 s65, s37, 3
  s_add_u32 s77, s77, s65
  s_add_u32 s77, s77, 17825792
  s_lshl_b32 s60, s46, 13
  s_lshl_b32 s65, s49, 12
  s_add_u32 s60, s60, s65
  s_add_u32 s60, s60, 86016
  v_lshlrev_b32 v18, 7, v2
  v_lshl_add_u32 v18, v3, 3, v18
  v_add_u32 v18, s60, v18
  v_bfe_u32 v19, v2, 1, 3
  s_lshl_b32 s60, s48, 2
  v_xor_b32 v19, s60, v19
  v_xor_b32 v20, 0, v19
  v_lshl_add_u32 v238, v20, 4, v18
  v_xor_b32 v20, 1, v19
  v_lshl_add_u32 v239, v20, 4, v18
  v_xor_b32 v20, 2, v19
  v_lshl_add_u32 v158, v20, 4, v18
  v_xor_b32 v20, 3, v19
  v_lshl_add_u32 v159, v20, 4, v18
  s_add_u32 s89, s47, 7
  s_sub_u32 s89, s89, s44
  s_sub_u32 s60, s89, 7
  s_cmp_ge_u32 s89, 7
  s_cselect_b32 s89, s60, s89
  v_mov_b32 v208, -1
  v_mov_b32 v209, -1
  v_mov_b32 v210, -1
  v_mov_b32 v211, -1
  v_lshrrev_b32 v18, 3, v1
  v_min_u32 v18, 2, v18
  v_bfe_u32 v19, v1, 1, 2
  v_min_u32 v19, 2, v19
  v_cmp_gt_u32 vcc, 2, v18
  v_max_u32 v20, 1, v19
  s_nop 0
  v_cndmask_b32 v19, v19, v20, vcc
  v_mul_u32_u24 v19, 448, v19
  v_and_b32 v20, 1, v1
  v_mul_u32_u24 v20, 31, v20
  s_mul_i32 s60, s37, 7
  s_lshr_b32 s78, s60, 1
  s_lshl_b32 s60, s78, 3
  v_add3_u32 v19, v19, v20, s60
  v_mul_u32_u24 v19, 2731, v19
  v_lshrrev_b32 v19, 18, v19
  v_min_u32 v19, 13, v19
  v_add_u32 v20, s36, v18
  v_cmp_gt_u32 vcc, 2, v20
  v_subrev_u32 v20, 2, v20
  v_mov_b32 v21, s36
  v_cndmask_b32 v20, v20, v21, vcc
  v_lshlrev_b32 v20, 9, v20
  v_lshl_add_u32 v20, v19, 3, v20
  s_lshl_b32 s60, s45, 7
  s_add_u32 s60, s60, 17825792
  v_add_u32 v27, s60, v20
  s_mul_i32 s86, s73, 86016
  s_lshl_b32 s65, s78, 9
  s_add_u32 s86, s86, s65
  s_sub_u32 s85, s86, 344064
  s_sub_u32 s84, s86, 688128
  s_cmp_lt_u32 s36, 1
  s_cselect_b32 s85, 0x40000000, s85
  s_cmp_lt_u32 s36, 2
  s_cselect_b32 s84, 0x40000000, s84
  s_lshl_b32 s87, s45, 11
  s_barrier
  ds_read_b128 v[80:83], v148 offset:0
  ds_read_b64_tr_b16 v[84:85], v152 offset:0
  ds_read_b64_tr_b16 v[86:87], v152 offset:768
  ds_read_b64_tr_b16 v[88:89], v152 offset:64
  ds_read_b64_tr_b16 v[90:91], v152 offset:832
  ds_read_b64_tr_b16 v[92:93], v152 offset:128
  ds_read_b64_tr_b16 v[94:95], v152 offset:896
  ds_read_b128 v[96:99], v149 offset:0
  ds_read_b64_tr_b16 v[100:101], v152 offset:3072
  ds_read_b64_tr_b16 v[102:103], v152 offset:3840
  ds_read_b64_tr_b16 v[104:105], v152 offset:3136
  ds_read_b64_tr_b16 v[106:107], v152 offset:3904
  ds_read_b64_tr_b16 v[108:109], v152 offset:3200
  ds_read_b64_tr_b16 v[110:111], v152 offset:3968
  s_waitcnt lgkmcnt(7)
  v_mfma_f32_32x32x16_bf16 v[32:47], v[84:87], v[80:83], 0
  v_mfma_f32_32x32x16_bf16 v[48:63], v[88:91], v[80:83], 0
  v_mfma_f32_32x32x16_bf16 v[64:79], v[92:95], v[80:83], 0
  ds_read_b128 v[112:115], v150 offset:0
  ds_read_b64_tr_b16 v[116:117], v152 offset:6144
  ds_read_b64_tr_b16 v[118:119], v152 offset:6912
  ds_read_b64_tr_b16 v[120:121], v152 offset:6208
  ds_read_b64_tr_b16 v[122:123], v152 offset:6976
  ds_read_b64_tr_b16 v[124:125], v152 offset:6272
  ds_read_b64_tr_b16 v[126:127], v152 offset:7040
  s_waitcnt lgkmcnt(7)
  v_mfma_f32_32x32x16_bf16 v[32:47], v[100:103], v[96:99], v[32:47]
  v_mfma_f32_32x32x16_bf16 v[48:63], v[104:107], v[96:99], v[48:63]
  v_mfma_f32_32x32x16_bf16 v[64:79], v[108:111], v[96:99], v[64:79]
  ds_read_b128 v[128:131], v151 offset:0
  ds_read_b64_tr_b16 v[132:133], v152 offset:9216
  ds_read_b64_tr_b16 v[134:135], v152 offset:9984
  ds_read_b64_tr_b16 v[136:137], v152 offset:9280
  ds_read_b64_tr_b16 v[138:139], v152 offset:10048
  ds_read_b64_tr_b16 v[140:141], v152 offset:9344
  ds_read_b64_tr_b16 v[142:143], v152 offset:10112
  s_waitcnt lgkmcnt(7)
  v_mfma_f32_32x32x16_bf16 v[32:47], v[116:119], v[112:115], v[32:47]
  v_mfma_f32_32x32x16_bf16 v[48:63], v[120:123], v[112:115], v[48:63]
  v_mfma_f32_32x32x16_bf16 v[64:79], v[124:127], v[112:115], v[64:79]
  s_cmp_lg_u32 s89, 0
  s_nop 7
  s_nop 2
  s_cbranch_scc1 Lnoxr_1
  ds_read_b64 v[8:9], v238 offset:0
  ds_read_b64 v[10:11], v239 offset:0
  ds_read_b64 v[12:13], v158 offset:0
  ds_read_b64 v[14:15], v159 offset:0
Lnoxr_1:
  s_waitcnt lgkmcnt(0)
  s_barrier
  ds_read_b128 v[80:83], v148 offset:16384
  ds_read_b64_tr_b16 v[84:85], v152 offset:12288
  ds_read_b64_tr_b16 v[86:87], v152 offset:13056
  ds_read_b64_tr_b16 v[88:89], v152 offset:12352
  ds_read_b64_tr_b16 v[90:91], v152 offset:13120
  ds_read_b64_tr_b16 v[92:93], v152 offset:12416
  ds_read_b64_tr_b16 v[94:95], v152 offset:13184
  ds_read_b128 v[96:99], v149 offset:16384
  ds_read_b64_tr_b16 v[100:101], v152 offset:15360
  ds_read_b64_tr_b16 v[102:103], v152 offset:16128
  ds_read_b64_tr_b16 v[104:105], v152 offset:15424
  ds_read_b64_tr_b16 v[106:107], v152 offset:16192
  ds_read_b64_tr_b16 v[108:109], v152 offset:15488
  ds_read_b64_tr_b16 v[110:111], v152 offset:16256
  v_mfma_f32_32x32x16_bf16 v[32:47], v[132:135], v[128:131], v[32:47]
  v_mfma_f32_32x32x16_bf16 v[48:63], v[136:139], v[128:131], v[48:63]
  v_mfma_f32_32x32x16_bf16 v[64:79], v[140:143], v[128:131], v[64:79]
  s_waitcnt lgkmcnt(7)
  v_mfma_f32_32x32x16_bf16 v[32:47], v[84:87], v[80:83], v[32:47]
  v_mfma_f32_32x32x16_bf16 v[48:63], v[88:91], v[80:83], v[48:63]
  v_mfma_f32_32x32x16_bf16 v[64:79], v[92:95], v[80:83], v[64:79]
  ds_read_b128 v[112:115], v150 offset:16384
  ds_read_b64_tr_b16 v[116:117], v152 offset:18432
  ds_read_b64_tr_b16 v[118:119], v152 offset:19200
  ds_read_b64_tr_b16 v[120:121], v152 offset:18496
  ds_read_b64_tr_b16 v[122:123], v152 offset:19264
  ds_read_b64_tr_b16 v[124:125], v152 offset:18560
  ds_read_b64_tr_b16 v[126:127], v152 offset:19328
  s_waitcnt lgkmcnt(7)
  v_mfma_f32_32x32x16_bf16 v[32:47], v[100:103], v[96:99], v[32:47]
  v_mfma_f32_32x32x16_bf16 v[48:63], v[104:107], v[96:99], v[48:63]
  v_mfma_f32_32x32x16_bf16 v[64:79], v[108:111], v[96:99], v[64:79]
  ds_read_b128 v[128:131], v151 offset:16384
  ds_read_b64_tr_b16 v[132:133], v152 offset:21504
  ds_read_b64_tr_b16 v[134:135], v152 offset:22272
  ds_read_b64_tr_b16 v[136:137], v152 offset:21568
  ds_read_b64_tr_b16 v[138:139], v152 offset:22336
  ds_read_b64_tr_b16 v[140:141], v152 offset:21632
  ds_read_b64_tr_b16 v[142:143], v152 offset:22400
  s_waitcnt lgkmcnt(7)
  v_mfma_f32_32x32x16_bf16 v[32:47], v[116:119], v[112:115], v[32:47]
  v_mfma_f32_32x32x16_bf16 v[48:63], v[120:123], v[112:115], v[48:63]
  v_mfma_f32_32x32x16_bf16 v[64:79], v[124:127], v[112:115], v[64:79]
  s_cmp_lg_u32 s89, 1
  s_nop 7
  s_nop 2
  s_cbranch_scc1 Lnoxr_2
  ds_read_b64 v[8:9], v238 offset:16384
  ds_read_b64 v[10:11], v239 offset:16384
  ds_read_b64 v[12:13], v158 offset:16384
  ds_read_b64 v[14:15], v159 offset:16384
Lnoxr_2:
  s_waitcnt lgkmcnt(0)
  s_barrier
  ds_read_b128 v[80:83], v148 offset:32768
  ds_read_b64_tr_b16 v[84:85], v152 offset:24576
  ds_read_b64_tr_b16 v[86:87], v152 offset:25344
  ds_read_b64_tr_b16 v[88:89], v152 offset:24640
  ds_read_b64_tr_b16 v[90:91], v152 offset:25408
  ds_read_b64_tr_b16 v[92:93], v152 offset:24704
  ds_read_b64_tr_b16 v[94:95], v152 offset:25472
  ds_read_b128 v[96:99], v149 offset:32768
  ds_read_b64_tr_b16 v[100:101], v152 offset:27648
  ds_read_b64_tr_b16 v[102:103], v152 offset:28416
  ds_read_b64_tr_b16 v[104:105], v152 offset:27712
  ds_read_b64_tr_b16 v[106:107], v152 offset:28480
  ds_read_b64_tr_b16 v[108:109], v152 offset:27776
  ds_read_b64_tr_b16 v[110:111], v152 offset:28544
  v_mfma_f32_32x32x16_bf16 v[32:47], v[132:135], v[128:131], v[32:47]
  v_mfma_f32_32x32x16_bf16 v[48:63], v[136:139], v[128:131], v[48:63]
  v_mfma_f32_32x32x16_bf16 v[64:79], v[140:143], v[128:131], v[64:79]
  buffer_store_dwordx4 v[208:211], v6, s[32:35], s74 offen offset:0 sc1
  buffer_store_dwordx4 v[208:211], v6, s[32:35], s74 offen offset:1024 sc1
  buffer_store_dwordx4 v[208:211], v6, s[32:35], s74 offen offset:2048 sc1
  buffer_store_dwordx4 v[208:211], v6, s[32:35], s74 offen offset:3072 sc1
  buffer_store_dwordx4 v[208:211], v6, s[32:35], s76 offen offset:0 sc1
  buffer_store_dwordx4 v[208:211], v6, s[32:35], s76 offen offset:1024 sc1
  buffer_load_dwordx2 v[16:17], v24, s[28:31], 0 offen sc1
  s_waitcnt lgkmcnt(7)
  v_mfma_f32_32x32x16_bf16 v[32:47], v[84:87], v[80:83], v[32:47]
  v_mfma_f32_32x32x16_bf16 v[48:63], v[88:91], v[80:83], v[48:63]
  v_mfma_f32_32x32x16_bf16 v[64:79], v[92:95], v[80:83], v[64:79]
  ds_read_b128 v[112:115], v150 offset:32768
  ds_read_b64_tr_b16 v[116:117], v152 offset:30720
  ds_read_b64_tr_b16 v[118:119], v152 offset:31488
  ds_read_b64_tr_b16 v[120:121], v152 offset:30784
  ds_read_b64_tr_b16 v[122:123], v152 offset:31552
  ds_read_b64_tr_b16 v[124:125], v152 offset:30848
  ds_read_b64_tr_b16 v[126:127], v152 offset:31616
  s_waitcnt lgkmcnt(7)
  v_mfma_f32_32x32x16_bf16 v[32:47], v[100:103], v[96:99], v[32:47]
  v_mfma_f32_32x32x16_bf16 v[48:63], v[104:107], v[96:99], v[48:63]
  v_mfma_f32_32x32x16_bf16 v[64:79], v[108:111], v[96:99], v[64:79]
  ds_read_b128 v[128:131], v151 offset:32768
  ds_read_b64_tr_b16 v[132:133], v152 offset:33792
  ds_read_b64_tr_b16 v[134:135], v152 offset:34560
  ds_read_b64_tr_b16 v[136:137], v152 offset:33856
  ds_read_b64_tr_b16 v[138:139], v152 offset:34624
  ds_read_b64_tr_b16 v[140:141], v152 offset:33920
  ds_read_b64_tr_b16 v[142:143], v152 offset:34688
  s_waitcnt lgkmcnt(7)
  v_mfma_f32_32x32x16_bf16 v[32:47], v[116:119], v[112:115], v[32:47]
  v_mfma_f32_32x32x16_bf16 v[48:63], v[120:123], v[112:115], v[48:63]
  v_mfma_f32_32x32x16_bf16 v[64:79], v[124:127], v[112:115], v[64:79]
  s_cmp_lg_u32 s89, 2
  s_nop 7
  s_nop 2
  s_cbranch_scc1 Lnoxr_3
  ds_read_b64 v[8:9], v238 offset:32768
  ds_read_b64 v[10:11], v239 offset:32768
  ds_read_b64 v[12:13], v158 offset:32768
  ds_read_b64 v[14:15], v159 offset:32768
Lnoxr_3:
  s_waitcnt lgkmcnt(0)
  s_barrier
  ds_read_b128 v[80:83], v148 offset:49152
  ds_read_b64_tr_b16 v[84:85], v152 offset:36864
  ds_read_b64_tr_b16 v[86:87], v152 offset:37632
  ds_read_b64_tr_b16 v[88:89], v152 offset:36928
  ds_read_b64_tr_b16 v[90:91], v152 offset:37696
  ds_read_b64_tr_b16 v[92:93], v152 offset:36992
  ds_read_b64_tr_b16 v[94:95], v152 offset:37760
  ds_read_b128 v[96:99], v149 offset:49152
  ds_read_b64_tr_b16 v[100:101], v152 offset:39936
  ds_read_b64_tr_b16 v[102:103], v152 offset:40704
  ds_read_b64_tr_b16 v[104:105], v152 offset:40000
  ds_read_b64_tr_b16 v[106:107], v152 offset:40768
  ds_read_b64_tr_b16 v[108:109], v152 offset:40064
  ds_read_b64_tr_b16 v[110:111], v152 offset:40832
  v_mfma_f32_32x32x16_bf16 v[32:47], v[132:135], v[128:131], v[32:47]
  v_mfma_f32_32x32x16_bf16 v[48:63], v[136:139], v[128:131], v[48:63]
  v_mfma_f32_32x32x16_bf16 v[64:79], v[140:143], v[128:131], v[64:79]
  s_waitcnt lgkmcnt(7)
  v_mfma_f32_32x32x16_bf16 v[32:47], v[84:87], v[80:83], v[32:47]
  v_mfma_f32_32x32x16_bf16 v[48:63], v[88:91], v[80:83], v[48:63]
  v_mfma_f32_32x32x16_bf16 v[64:79], v[92:95], v[80:83], v[64:79]
  ds_read_b128 v[112:115], v150 offset:49152
  ds_read_b64_tr_b16 v[116:117], v152 offset:43008
  ds_read_b64_tr_b16 v[118:119], v152 offset:43776
  ds_read_b64_tr_b16 v[120:121], v152 offset:43072
  ds_read_b64_tr_b16 v[122:123], v152 offset:43840
  ds_read_b64_tr_b16 v[124:125], v152 offset:43136
  ds_read_b64_tr_b16 v[126:127], v152 offset:43904
  s_waitcnt lgkmcnt(7)
  v_mfma_f32_32x32x16_bf16 v[32:47], v[100:103], v[96:99], v[32:47]
  v_mfma_f32_32x32x16_bf16 v[48:63], v[104:107], v[96:99], v[48:63]
  v_mfma_f32_32x32x16_bf16 v[64:79], v[108:111], v[96:99], v[64:79]
  ds_read_b128 v[128:131], v151 offset:49152
  ds_read_b64_tr_b16 v[132:133], v152 offset:46080
  ds_read_b64_tr_b16 v[134:135], v152 offset:46848
  ds_read_b64_tr_b16 v[136:137], v152 offset:46144
  ds_read_b64_tr_b16 v[138:139], v152 offset:46912
  ds_read_b64_tr_b16 v[140:141], v152 offset:46208
  ds_read_b64_tr_b16 v[142:143], v152 offset:46976
  s_waitcnt lgkmcnt(7)
  v_mfma_f32_32x32x16_bf16 v[32:47], v[116:119], v[112:115], v[32:47]
  v_mfma_f32_32x32x16_bf16 v[48:63], v[120:123], v[112:115], v[48:63]
  v_mfma_f32_32x32x16_bf16 v[64:79], v[124:127], v[112:115], v[64:79]
  s_cmp_lg_u32 s89, 3
  s_nop 7
  s_nop 2
  s_cbranch_scc1 Lnoxr_4
  ds_read_b64 v[8:9], v238 offset:49152
  ds_read_b64 v[10:11], v239 offset:49152
  ds_read_b64 v[12:13], v158 offset:49152
  ds_read_b64 v[14:15], v159 offset:49152
Lnoxr_4:
  s_waitcnt lgkmcnt(0)
  s_barrier
  ds_read_b128 v[80:83], v148 offset:0
  ds_read_b64_tr_b16 v[84:85], v152 offset:49152
  ds_read_b64_tr_b16 v[86:87], v152 offset:49920
  ds_read_b64_tr_b16 v[88:89], v152 offset:49216
  ds_read_b64_tr_b16 v[90:91], v152 offset:49984
  ds_read_b64_tr_b16 v[92:93], v152 offset:49280
  ds_read_b64_tr_b16 v[94:95], v152 offset:50048
  ds_read_b128 v[96:99], v149 offset:0
  ds_read_b64_tr_b16 v[100:101], v152 offset:52224
  ds_read_b64_tr_b16 v[102:103], v152 offset:52992
  ds_read_b64_tr_b16 v[104:105], v152 offset:52288
  ds_read_b64_tr_b16 v[106:107], v152 offset:53056
  ds_read_b64_tr_b16 v[108:109], v152 offset:52352
  ds_read_b64_tr_b16 v[110:111], v152 offset:53120
  v_mfma_f32_32x32x16_bf16 v[32:47], v[132:135], v[128:131], v[32:47]
  v_mfma_f32_32x32x16_bf16 v[48:63], v[136:139], v[128:131], v[48:63]
  v_mfma_f32_32x32x16_bf16 v[64:79], v[140:143], v[128:131], v[64:79]
  s_waitcnt lgkmcnt(7)
  v_mfma_f32_32x32x16_bf16 v[32:47], v[84:87], v[80:83], v[32:47]
  v_mfma_f32_32x32x16_bf16 v[48:63], v[88:91], v[80:83], v[48:63]
  v_mfma_f32_32x32x16_bf16 v[64:79], v[92:95], v[80:83], v[64:79]
  ds_read_b128 v[112:115], v150 offset:0
  ds_read_b64_tr_b16 v[116:117], v152 offset:55296
  ds_read_b64_tr_b16 v[118:119], v152 offset:56064
  ds_read_b64_tr_b16 v[120:121], v152 offset:55360
  ds_read_b64_tr_b16 v[122:123], v152 offset:56128
  ds_read_b64_tr_b16 v[124:125], v152 offset:55424
  ds_read_b64_tr_b16 v[126:127], v152 offset:56192
  s_waitcnt lgkmcnt(7)
  v_mfma_f32_32x32x16_bf16 v[32:47], v[100:103], v[96:99], v[32:47]
  v_mfma_f32_32x32x16_bf16 v[48:63], v[104:107], v[96:99], v[48:63]
  v_mfma_f32_32x32x16_bf16 v[64:79], v[108:111], v[96:99], v[64:79]
  ds_read_b128 v[128:131], v151 offset:0
  ds_read_b64_tr_b16 v[132:133], v152 offset:58368
  ds_read_b64_tr_b16 v[134:135], v152 offset:59136
  ds_read_b64_tr_b16 v[136:137], v152 offset:58432
  ds_read_b64_tr_b16 v[138:139], v152 offset:59200
  ds_read_b64_tr_b16 v[140:141], v152 offset:58496
  ds_read_b64_tr_b16 v[142:143], v152 offset:59264
  s_waitcnt lgkmcnt(7)
  v_mfma_f32_32x32x16_bf16 v[32:47], v[116:119], v[112:115], v[32:47]
  v_mfma_f32_32x32x16_bf16 v[48:63], v[120:123], v[112:115], v[48:63]
  v_mfma_f32_32x32x16_bf16 v[64:79], v[124:127], v[112:115], v[64:79]
  s_mov_b32 s58, 0x20000
  s_nop 7
  s_nop 2
Lep_m:
  s_waitcnt vmcnt(0)
  v_readfirstlane_b32 s42, v16
  v_readfirstlane_b32 s43, v17
  s_nop 0
  s_cmp_lg_u32 s42, 0
  s_nop 2
  s_cbranch_scc1 Lepd_m
  s_sleep 4
  buffer_load_dwordx2 v[16:17], v24, s[28:31], 0 offen sc1
  s_sub_u32 s58, s58, 1
  s_cmp_lg_u32 s58, 0
  s_cbranch_scc1 Lep_m
Lepd_m:
  v_mov_b32 v20, 162176
  ds_write_b64 v20, v[16:17]
  v_or_b32 v16, s40, v16
  s_mov_b64 exec, 1
  buffer_store_dwordx2 v[16:17], v24, s[32:35], s77 offen sc1
  s_mov_b64 exec, -1
  s_cmp_lg_u32 s89, 4
  s_cbranch_scc1 Lnoxr_5
  ds_read_b64 v[8:9], v238 offset:0
  ds_read_b64 v[10:11], v239 offset:0
  ds_read_b64 v[12:13], v158 offset:0
  ds_read_b64 v[14:15], v159 offset:0
Lnoxr_5:
  s_waitcnt lgkmcnt(0)
  s_barrier
  ds_read_b128 v[80:83], v148 offset:16384
  ds_read_b64_tr_b16 v[84:85], v153 offset:0
  ds_read_b64_tr_b16 v[86:87], v153 offset:768
  ds_read_b64_tr_b16 v[88:89], v153 offset:64
  ds_read_b64_tr_b16 v[90:91], v153 offset:832
  ds_read_b64_tr_b16 v[92:93], v153 offset:128
  ds_read_b64_tr_b16 v[94:95], v153 offset:896
  ds_read_b128 v[96:99], v149 offset:16384
  ds_read_b64_tr_b16 v[100:101], v153 offset:3072
  ds_read_b64_tr_b16 v[102:103], v153 offset:3840
  ds_read_b64_tr_b16 v[104:105], v153 offset:3136
  ds_read_b64_tr_b16 v[106:107], v153 offset:3904
  ds_read_b64_tr_b16 v[108:109], v153 offset:3200
  ds_read_b64_tr_b16 v[110:111], v153 offset:3968
  v_mfma_f32_32x32x16_bf16 v[32:47], v[132:135], v[128:131], v[32:47]
  v_mfma_f32_32x32x16_bf16 v[48:63], v[136:139], v[128:131], v[48:63]
  v_mfma_f32_32x32x16_bf16 v[64:79], v[140:143], v[128:131], v[64:79]
  s_waitcnt lgkmcnt(7)
  v_mfma_f32_32x32x16_bf16 v[32:47], v[84:87], v[80:83], v[32:47]
  v_mfma_f32_32x32x16_bf16 v[48:63], v[88:91], v[80:83], v[48:63]
  v_mfma_f32_32x32x16_bf16 v[64:79], v[92:95], v[80:83], v[64:79]
  ds_read_b128 v[112:115], v150 offset:16384
  ds_read_b64_tr_b16 v[116:117], v153 offset:6144
  ds_read_b64_tr_b16 v[118:119], v153 offset:6912
  ds_read_b64_tr_b16 v[120:121], v153 offset:6208
  ds_read_b64_tr_b16 v[122:123], v153 offset:6976
  ds_read_b64_tr_b16 v[124:125], v153 offset:6272
  ds_read_b64_tr_b16 v[126:127], v153 offset:7040
  s_waitcnt lgkmcnt(7)
  v_mfma_f32_32x32x16_bf16 v[32:47], v[100:103], v[96:99], v[32:47]
  v_mfma_f32_32x32x16_bf16 v[48:63], v[104:107], v[96:99], v[48:63]
  v_mfma_f32_32x32x16_bf16 v[64:79], v[108:111], v[96:99], v[64:79]
  ds_read_b128 v[128:131], v151 offset:16384
  ds_read_b64_tr_b16 v[132:133], v153 offset:9216
  ds_read_b64_tr_b16 v[134:135], v153 offset:9984
  ds_read_b64_tr_b16 v[136:137], v153 offset:9280
  ds_read_b64_tr_b16 v[138:139], v153 offset:10048
  ds_read_b64_tr_b16 v[140:141], v153 offset:9344
  ds_read_b64_tr_b16 v[142:143], v153 offset:10112
  s_waitcnt lgkmcnt(7)
  v_mfma_f32_32x32x16_bf16 v[32:47], v[116:119], v[112:115], v[32:47]
  v_mfma_f32_32x32x16_bf16 v[48:63], v[120:123], v[112:115], v[48:63]
  v_mfma_f32_32x32x16_bf16 v[64:79], v[124:127], v[112:115], v[64:79]
  s_cmp_lg_u32 s89, 5
  s_nop 7
  s_nop 2
  s_cbranch_scc1 Lnoxr_6
  ds_read_b64 v[8:9], v238 offset:16384
  ds_read_b64 v[10:11], v239 offset:16384
  ds_read_b64 v[12:13], v158 offset:16384
  ds_read_b64 v[14:15], v159 offset:16384
Lnoxr_6:
  s_waitcnt lgkmcnt(0)
  s_barrier
  ds_read_b128 v[80:83], v148 offset:32768
  ds_read_b64_tr_b16 v[84:85], v153 offset:12288
  ds_read_b64_tr_b16 v[86:87], v153 offset:13056
  ds_read_b64_tr_b16 v[88:89], v153 offset:12352
  ds_read_b64_tr_b16 v[90:91], v153 offset:13120
  ds_read_b64_tr_b16 v[92:93], v153 offset:12416
  ds_read_b64_tr_b16 v[94:95], v153 offset:13184
  ds_read_b128 v[96:99], v149 offset:32768
  ds_read_b64_tr_b16 v[100:101], v153 offset:15360
  ds_read_b64_tr_b16 v[102:103], v153 offset:16128
  ds_read_b64_tr_b16 v[104:105], v153 offset:15424
  ds_read_b64_tr_b16 v[106:107], v153 offset:16192
  ds_read_b64_tr_b16 v[108:109], v153 offset:15488
  ds_read_b64_tr_b16 v[110:111], v153 offset:16256
  v_mfma_f32_32x32x16_bf16 v[32:47], v[132:135], v[128:131], v[32:47]
  v_mfma_f32_32x32x16_bf16 v[48:63], v[136:139], v[128:131], v[48:63]
  v_mfma_f32_32x32x16_bf16 v[64:79], v[140:143], v[128:131], v[64:79]
  buffer_load_dwordx2 v[236:237], v27, s[32:35], 0 offen sc1
  s_waitcnt lgkmcnt(7)
  v_mfma_f32_32x32x16_bf16 v[32:47], v[84:87], v[80:83], v[32:47]
  v_mfma_f32_32x32x16_bf16 v[48:63], v[88:91], v[80:83], v[48:63]
  v_mfma_f32_32x32x16_bf16 v[64:79], v[92:95], v[80:83], v[64:79]
  ds_read_b128 v[112:115], v150 offset:32768
  ds_read_b64_tr_b16 v[116:117], v153 offset:18432
  ds_read_b64_tr_b16 v[118:119], v153 offset:19200
  ds_read_b64_tr_b16 v[120:121], v153 offset:18496
  ds_read_b64_tr_b16 v[122:123], v153 offset:19264
  ds_read_b64_tr_b16 v[124:125], v153 offset:18560
  ds_read_b64_tr_b16 v[126:127], v153 offset:19328
  s_waitcnt lgkmcnt(7)
  v_mfma_f32_32x32x16_bf16 v[32:47], v[100:103], v[96:99], v[32:47]
  v_mfma_f32_32x32x16_bf16 v[48:63], v[104:107], v[96:99], v[48:63]
  v_mfma_f32_32x32x16_bf16 v[64:79], v[108:111], v[96:99], v[64:79]
  ds_read_b128 v[128:131], v151 offset:32768
  ds_read_b64_tr_b16 v[132:133], v153 offset:21504
  ds_read_b64_tr_b16 v[134:135], v153 offset:22272
  ds_read_b64_tr_b16 v[136:137], v153 offset:21568
  ds_read_b64_tr_b16 v[138:139], v153 offset:22336
  ds_read_b64_tr_b16 v[140:141], v153 offset:21632
  ds_read_b64_tr_b16 v[142:143], v153 offset:22400
  ds_read_b32 v232, v154
  ds_read_b32 v234, v154 offset:128
  s_waitcnt lgkmcnt(9)
  v_mfma_f32_32x32x16_bf16 v[32:47], v[116:119], v[112:115], v[32:47]
  v_mfma_f32_32x32x16_bf16 v[48:63], v[120:123], v[112:115], v[48:63]
  v_mfma_f32_32x32x16_bf16 v[64:79], v[124:127], v[112:115], v[64:79]
  s_waitcnt lgkmcnt(2)
  ds_read_b128 v[160:163], v155 offset:0
  ds_read_b128 v[164:167], v155 offset:32
  ds_read_b128 v[168:171], v155 offset:64
  ds_read_b128 v[172:175], v155 offset:96
  ds_read_b128 v[176:179], v155 offset:128
  ds_read_b128 v[180:183], v155 offset:160
  ds_read_b128 v[184:187], v155 offset:192
  ds_read_b128 v[188:191], v155 offset:224
  ds_read_b128 v[192:195], v155 offset:256
  ds_read_b128 v[196:199], v155 offset:288
  ds_read_b128 v[200:203], v155 offset:320
  ds_read_b128 v[204:207], v155 offset:352
  v_mfma_f32_32x32x16_bf16 v[32:47], v[132:135], v[128:131], v[32:47]
  v_mfma_f32_32x32x16_bf16 v[48:63], v[136:139], v[128:131], v[48:63]
  v_mfma_f32_32x32x16_bf16 v[64:79], v[140:143], v[128:131], v[64:79]
  s_waitcnt lgkmcnt(12)
  v_mul_f32 v232, v232, v234
  v_mov_b32 v235, v234
  v_mov_b32 v233, v232
  s_waitcnt lgkmcnt(8)
  v_pk_mul_f32 v[160:161], v[160:161], v[232:233]
  v_pk_mul_f32 v[162:163], v[162:163], v[232:233]
  v_pk_mul_f32 v[164:165], v[164:165], v[232:233]
  v_pk_mul_f32 v[166:167], v[166:167], v[232:233]
  v_pk_mul_f32 v[168:169], v[168:169], v[232:233]
  v_pk_mul_f32 v[170:171], v[170:171], v[232:233]
  v_pk_mul_f32 v[172:173], v[172:173], v[232:233]
  v_pk_mul_f32 v[174:175], v[174:175], v[232:233]
  s_waitcnt lgkmcnt(4)
  v_pk_mul_f32 v[176:177], v[176:177], v[232:233]
  v_pk_mul_f32 v[178:179], v[178:179], v[232:233]
  v_pk_mul_f32 v[180:181], v[180:181], v[232:233]
  v_pk_mul_f32 v[182:183], v[182:183], v[232:233]
  v_pk_mul_f32 v[184:185], v[184:185], v[232:233]
  v_pk_mul_f32 v[186:187], v[186:187], v[232:233]
  v_pk_mul_f32 v[188:189], v[188:189], v[232:233]
  v_pk_mul_f32 v[190:191], v[190:191], v[232:233]
  s_waitcnt lgkmcnt(0)
  v_pk_mul_f32 v[192:193], v[192:193], v[232:233]
  v_pk_mul_f32 v[194:195], v[194:195], v[232:233]
  v_pk_mul_f32 v[196:197], v[196:197], v[232:233]
  v_pk_mul_f32 v[198:199], v[198:199], v[232:233]
  v_pk_mul_f32 v[200:201], v[200:201], v[232:233]
  v_pk_mul_f32 v[202:203], v[202:203], v[232:233]
  v_pk_mul_f32 v[204:205], v[204:205], v[232:233]
  v_pk_mul_f32 v[206:207], v[206:207], v[232:233]
  v_pk_fma_f32 v[32:33], v[32:33], v[234:235], v[160:161]
  v_pk_fma_f32 v[34:35], v[34:35], v[234:235], v[162:163]
  v_pk_fma_f32 v[36:37], v[36:37], v[234:235], v[164:165]
  v_pk_fma_f32 v[38:39], v[38:39], v[234:235], v[166:167]
  v_pk_fma_f32 v[40:41], v[40:41], v[234:235], v[168:169]
  v_pk_fma_f32 v[42:43], v[42:43], v[234:235], v[170:171]
  v_pk_fma_f32 v[44:45], v[44:45], v[234:235], v[172:173]
  v_pk_fma_f32 v[46:47], v[46:47], v[234:235], v[174:175]
  v_cvt_pk_bf16_f32 v208, v32, v33
  v_cvt_pk_bf16_f32 v209, v34, v35
  v_cvt_pk_bf16_f32 v210, v36, v37
  v_cvt_pk_bf16_f32 v211, v38, v39
  v_cvt_pk_bf16_f32 v212, v40, v41
  v_cvt_pk_bf16_f32 v213, v42, v43
  v_cvt_pk_bf16_f32 v214, v44, v45
  v_cvt_pk_bf16_f32 v215, v46, v47
  v_permlane32_swap_b32 v208, v210
  v_permlane32_swap_b32 v209, v211
  v_permlane32_swap_b32 v212, v214
  v_permlane32_swap_b32 v213, v215
  buffer_store_dwordx4 v[208:211], v156, s[32:35], s74 offen offset:0 sc1
  buffer_store_dwordx4 v[212:215], v156, s[32:35], s74 offen offset:1024 sc1
  v_pk_fma_f32 v[48:49], v[48:49], v[234:235], v[176:177]
  v_pk_fma_f32 v[50:51], v[50:51], v[234:235], v[178:179]
  v_pk_fma_f32 v[52:53], v[52:53], v[234:235], v[180:181]
  v_pk_fma_f32 v[54:55], v[54:55], v[234:235], v[182:183]
  v_pk_fma_f32 v[56:57], v[56:57], v[234:235], v[184:185]
  v_pk_fma_f32 v[58:59], v[58:59], v[234:235], v[186:187]
  v_pk_fma_f32 v[60:61], v[60:61], v[234:235], v[188:189]
  v_pk_fma_f32 v[62:63], v[62:63], v[234:235], v[190:191]
  v_cvt_pk_bf16_f32 v216, v48, v49
  v_cvt_pk_bf16_f32 v217, v50, v51
  v_cvt_pk_bf16_f32 v218, v52, v53
  v_cvt_pk_bf16_f32 v219, v54, v55
  v_cvt_pk_bf16_f32 v220, v56, v57
  v_cvt_pk_bf16_f32 v221, v58, v59
  v_cvt_pk_bf16_f32 v222, v60, v61
  v_cvt_pk_bf16_f32 v223, v62, v63
  v_permlane32_swap_b32 v216, v218
  v_permlane32_swap_b32 v217, v219
  v_permlane32_swap_b32 v220, v222
  v_permlane32_swap_b32 v221, v223
  buffer_store_dwordx4 v[216:219], v156, s[32:35], s74 offen offset:2048 sc1
  buffer_store_dwordx4 v[220:223], v156, s[32:35], s74 offen offset:3072 sc1
  v_pk_fma_f32 v[64:65], v[64:65], v[234:235], v[192:193]
  v_pk_fma_f32 v[66:67], v[66:67], v[234:235], v[194:195]
  v_pk_fma_f32 v[68:69], v[68:69], v[234:235], v[196:197]
  v_pk_fma_f32 v[70:71], v[70:71], v[234:235], v[198:199]
  v_pk_fma_f32 v[72:73], v[72:73], v[234:235], v[200:201]
  v_pk_fma_f32 v[74:75], v[74:75], v[234:235], v[202:203]
  v_pk_fma_f32 v[76:77], v[76:77], v[234:235], v[204:205]
  v_pk_fma_f32 v[78:79], v[78:79], v[234:235], v[206:207]
  v_cvt_pk_bf16_f32 v224, v64, v65
  v_cvt_pk_bf16_f32 v225, v66, v67
  v_cvt_pk_bf16_f32 v226, v68, v69
  v_cvt_pk_bf16_f32 v227, v70, v71
  v_cvt_pk_bf16_f32 v228, v72, v73
  v_cvt_pk_bf16_f32 v229, v74, v75
  v_cvt_pk_bf16_f32 v230, v76, v77
  v_cvt_pk_bf16_f32 v231, v78, v79
  v_permlane32_swap_b32 v224, v226
  v_permlane32_swap_b32 v225, v227
  v_permlane32_swap_b32 v228, v230
  v_permlane32_swap_b32 v229, v231
  buffer_store_dwordx4 v[224:227], v156, s[32:35], s76 offen offset:0 sc1
  buffer_store_dwordx4 v[228:231], v156, s[32:35], s76 offen offset:1024 sc1
  s_cmp_lg_u32 s89, 6
  s_nop 0
  s_cbranch_scc1 Lnoxr_7
  ds_read_b64 v[8:9], v238 offset:32768
  ds_read_b64 v[10:11], v239 offset:32768
  ds_read_b64 v[12:13], v158 offset:32768
  ds_read_b64 v[14:15], v159 offset:32768
Lnoxr_7:
  s_waitcnt lgkmcnt(0)
  s_barrier
  s_waitcnt vmcnt(6)
  v_and_b32 v236, -8, v236
  v_cmp_ne_u64 vcc, s[42:43], v[236:237]
  s_nop 4
  s_cbranch_vccz Lfetch_go
Lfetch:
  s_mov_b32 s58, 0x20000
Lpoll_f1_8:
  buffer_load_dwordx2 v[20:21], v27, s[32:35], 0 offen sc1
  s_sub_u32 s58, s58, 1
  s_waitcnt vmcnt(0)
  v_and_b32 v20, -8, v20
  v_cmp_ne_u64 vcc, s[42:43], v[20:21]
  s_cmp_eq_u32 s58, 0
  s_nop 3
  s_cbranch_scc1 Lpolld_f1_9
  s_cbranch_vccnz Lpoll_f1_8
Lpolld_f1_9:
Lfetch_go:
  v_add_u32 v32, s57, v6
  v_add_u32 v33, s87, v6
  s_mov_b32 s58, 0x4000
  s_add_u32 m0, s87, 49152
  s_nop 0
  buffer_load_dwordx4 v6, s[32:35], s86 offen sc1 lds
  s_add_u32 m0, s87, 49152
  s_nop 0
  buffer_load_dwordx4 v6, s[32:35], s86 offen offset:1024 sc1 lds
  s_add_u32 s60, s86, 28672
  s_add_u32 s61, s86, 57344
  s_add_u32 m0, s57, 32768
  s_nop 0
  buffer_load_dwordx4 v6, s[32:35], s60 offen sc1 lds
  s_add_u32 m0, s57, 32768
  s_nop 0
  buffer_load_dwordx4 v6, s[32:35], s60 offen offset:1024 sc1 lds
  s_add_u32 m0, s57, 34816
  s_nop 0
  buffer_load_dwordx4 v6, s[32:35], s61 offen sc1 lds
  s_add_u32 m0, s57, 34816
  s_nop 0
  buffer_load_dwordx4 v6, s[32:35], s61 offen offset:1024 sc1 lds
  s_add_u32 s60, s85, 28672
  s_add_u32 s61, s85, 57344
  s_add_u32 m0, s57, 16384
  s_nop 0
  buffer_load_dwordx4 v6, s[32:35], s60 offen sc1 lds
  s_add_u32 m0, s57, 16384
  s_nop 0
  buffer_load_dwordx4 v6, s[32:35], s60 offen offset:1024 sc1 lds
  s_add_u32 m0, s57, 18432
  s_nop 0
  buffer_load_dwordx4 v6, s[32:35], s61 offen sc1 lds
  s_add_u32 m0, s57, 18432
  s_nop 0
  buffer_load_dwordx4 v6, s[32:35], s61 offen offset:1024 sc1 lds
  s_add_u32 s60, s84, 28672
  s_add_u32 s61, s84, 57344
  s_add_u32 m0, s57, 0
  s_nop 0
  buffer_load_dwordx4 v6, s[32:35], s60 offen sc1 lds
  s_add_u32 m0, s57, 0
  s_nop 0
  buffer_load_dwordx4 v6, s[32:35], s60 offen offset:1024 sc1 lds
  s_add_u32 m0, s57, 2048
  s_nop 0
  buffer_load_dwordx4 v6, s[32:35], s61 offen sc1 lds
  s_add_u32 m0, s57, 2048
  s_nop 0
  buffer_load_dwordx4 v6, s[32:35], s61 offen offset:1024 sc1 lds
  s_mul_i32 s64, s37, 7
  s_lshr_b32 s64, s64, 1
  v_add_u32 v21, s64, v5
  v_and_b32 v21, 1, v21
  v_mul_u32_u24 v21, 12, v21
  v_bfe_u32 v22, v4, 1, 1
  v_add_u32 v23, s64, v22
  v_and_b32 v23, 1, v23
  v_mul_u32_u24 v23, 12, v23
  s_add_u32 s60, s38, 0
  s_lshr_b32 s61, s60, 1
  s_lshl_b32 s61, s61, 12
  s_and_b32 s60, s60, 1
  s_lshl_b32 s60, s60, 4
  v_add_u32 v18, s60, v4
  v_xor_b32 v18, v18, v21
  v_lshlrev_b32 v18, 4, v18
  v_lshl_add_u32 v18, v5, 9, v18
  v_add_u32 v180, s61, v18
  s_lshr_b32 s62, s61, 1
  s_add_u32 s62, s62, 49152
  v_add_u32 v186, s62, v18
  v_lshrrev_b32 v18, 2, v4
  v_lshl_add_u32 v18, v5, 2, v18
  v_add_u32 v18, s60, v18
  v_xor_b32 v18, v18, v23
  v_lshlrev_b32 v18, 4, v18
  v_lshl_add_u32 v18, v22, 9, v18
  v_and_b32 v19, 1, v4
  v_lshl_add_u32 v18, v19, 3, v18
  v_add_u32 v184, s61, v18
  s_add_u32 s60, s38, 1
  s_lshr_b32 s61, s60, 1
  s_lshl_b32 s61, s61, 12
  s_and_b32 s60, s60, 1
  s_lshl_b32 s60, s60, 4
  v_add_u32 v18, s60, v4
  v_xor_b32 v18, v18, v21
  v_lshlrev_b32 v18, 4, v18
  v_lshl_add_u32 v18, v5, 9, v18
  v_add_u32 v181, s61, v18
  v_lshrrev_b32 v18, 2, v4
  v_lshl_add_u32 v18, v5, 2, v18
  v_add_u32 v18, s60, v18
  v_xor_b32 v18, v18, v23
  v_lshlrev_b32 v18, 4, v18
  v_lshl_add_u32 v18, v22, 9, v18
  v_and_b32 v19, 1, v4
  v_lshl_add_u32 v18, v19, 3, v18
  v_add_u32 v185, s61, v18
  s_and_b32 s60, s37, 1
  s_cmp_eq_u32 s60, 0
  s_cselect_b32 s80, 0, 0xffff
  s_mov_b32 s81, 0
  s_mov_b32 s82, 0
  s_cselect_b32 s83, 0xffff0000, 0
  v_mov_b32 v200, 0x3f803f80
  v_mov_b32 v201, 0x3f803f80
  v_mov_b32 v202, 0x3f803f80
  v_mov_b32 v203, 0x3f803f80
  v_mov_b32 v188, 0xf149f2ca
  v_lshlrev_b32 v18, 2, v5
  v_sub_u32 v18, v18, v4
  v_cmp_lt_i32 vcc, 0, v18
  s_nop 1
  v_cndmask_b32 v128, v188, v24, vcc
  v_cndmask_b32 v132, v24, v188, vcc
  v_cmp_lt_i32 vcc, -1, v18
  s_nop 1
  v_cndmask_b32 v129, v188, v24, vcc
  v_cndmask_b32 v133, v24, v188, vcc
  v_cmp_lt_i32 vcc, -2, v18
  s_nop 1
  v_cndmask_b32 v130, v188, v24, vcc
  v_cndmask_b32 v134, v24, v188, vcc
  v_cmp_lt_i32 vcc, -3, v18
  s_nop 1
  v_cndmask_b32 v131, v188, v24, vcc
  v_cndmask_b32 v135, v24, v188, vcc
  s_lshl_b32 s60, s36, 9
  s_add_u32 s60, s60, 17825792
  v_lshlrev_b32 v189, 3, v4
  v_add_u32 v189, s60, v189
  s_lshr_b32 s61, s38, 1
  s_and_b32 s62, s38, 1
  s_lshl_b32 s78, s36, 17
  s_lshl_b32 s65, s61, 15
  s_add_u32 s78, s78, s65
  s_lshl_b32 s65, s37, 11
  s_add_u32 s78, s78, s65
  s_lshl_b32 s65, s62, 8
  s_add_u32 s78, s78, s65
  s_add_u32 s78, s78, 6291456
  s_lshl_b32 s79, s36, 10
  s_lshl_b32 s65, s38, 7
  s_add_u32 s79, s79, s65
  s_lshl_b32 s65, s37, 3
  s_add_u32 s79, s79, s65
  s_add_u32 s79, s79, 17891328
  v_lshlrev_b32 v192, 9, v5
  v_lshl_add_u32 v192, v4, 4, v192
  v_mov_b32 v146, 0
  v_mov_b32 v147, 0
  s_nop 2
Lfetch_val:
  s_waitcnt vmcnt(8)
  ds_read_b128 v[36:39], v33 offset:49152
  ds_read_b128 v[40:43], v33 offset:50176
  ds_read_b128 v[44:47], v32 offset:32768
  ds_read_b128 v[48:51], v32 offset:33792
  ds_read_b128 v[52:55], v32 offset:34816
  ds_read_b128 v[56:59], v32 offset:35840
  s_waitcnt vmcnt(4)
  ds_read_b128 v[60:63], v32 offset:16384
  ds_read_b128 v[64:67], v32 offset:17408
  ds_read_b128 v[68:71], v32 offset:18432
  ds_read_b128 v[72:75], v32 offset:19456
  s_waitcnt vmcnt(0)
  ds_read_b128 v[76:79], v32 offset:0
  ds_read_b128 v[80:83], v32 offset:1024
  ds_read_b128 v[84:87], v32 offset:2048
  ds_read_b128 v[88:91], v32 offset:3072
  v_mov_b32 v34, 0
  v_mov_b32 v35, 0
  s_waitcnt lgkmcnt(8)
  v_max3_u32 v34, v34, v36, v37
  v_max3_u32 v35, v35, v38, v39
  v_max3_u32 v34, v34, v40, v41
  v_max3_u32 v35, v35, v42, v43
  v_max3_u32 v34, v34, v44, v45
  v_max3_u32 v35, v35, v46, v47
  v_max3_u32 v34, v34, v48, v49
  v_max3_u32 v35, v35, v50, v51
  v_max3_u32 v34, v34, v52, v53
  v_max3_u32 v35, v35, v54, v55
  v_max3_u32 v34, v34, v56, v57
  v_max3_u32 v35, v35, v58, v59
  s_waitcnt lgkmcnt(4)
  v_max3_u32 v34, v34, v60, v61
  v_max3_u32 v35, v35, v62, v63
  v_max3_u32 v34, v34, v64, v65
  v_max3_u32 v35, v35, v66, v67
  v_max3_u32 v34, v34, v68, v69
  v_max3_u32 v35, v35, v70, v71
  v_max3_u32 v34, v34, v72, v73
  v_max3_u32 v35, v35, v74, v75
  s_waitcnt lgkmcnt(0)
  v_max3_u32 v34, v34, v76, v77
  v_max3_u32 v35, v35, v78, v79
  v_max3_u32 v34, v34, v80, v81
  v_max3_u32 v35, v35, v82, v83
  v_max3_u32 v34, v34, v84, v85
  v_max3_u32 v35, v35, v86, v87
  v_max3_u32 v34, v34, v88, v89
  v_max3_u32 v35, v35, v90, v91
  v_max_u32 v34, v34, v35
  v_cmp_eq_u32 vcc, -1, v34
  s_sub_u32 s58, s58, 1
  s_cmp_eq_u32 s58, 0
  s_nop 2
  s_cbranch_scc1 Lfetch_done
  s_cbranch_vccz Lfetch_done
  s_add_u32 m0, s87, 49152
  s_nop 0
  buffer_load_dwordx4 v6, s[32:35], s86 offen sc1 lds
  s_add_u32 m0, s87, 49152
  s_nop 0
  buffer_load_dwordx4 v6, s[32:35], s86 offen offset:1024 sc1 lds
  s_add_u32 s60, s86, 28672
  s_add_u32 s61, s86, 57344
  s_add_u32 m0, s57, 32768
  s_nop 0
  buffer_load_dwordx4 v6, s[32:35], s60 offen sc1 lds
  s_add_u32 m0, s57, 32768
  s_nop 0
  buffer_load_dwordx4 v6, s[32:35], s60 offen offset:1024 sc1 lds
  s_add_u32 m0, s57, 34816
  s_nop 0
  buffer_load_dwordx4 v6, s[32:35], s61 offen sc1 lds
  s_add_u32 m0, s57, 34816
  s_nop 0
  buffer_load_dwordx4 v6, s[32:35], s61 offen offset:1024 sc1 lds
  s_add_u32 s60, s85, 28672
  s_add_u32 s61, s85, 57344
  s_add_u32 m0, s57, 16384
  s_nop 0
  buffer_load_dwordx4 v6, s[32:35], s60 offen sc1 lds
  s_add_u32 m0, s57, 16384
  s_nop 0
  buffer_load_dwordx4 v6, s[32:35], s60 offen offset:1024 sc1 lds
  s_add_u32 m0, s57, 18432
  s_nop 0
  buffer_load_dwordx4 v6, s[32:35], s61 offen sc1 lds
  s_add_u32 m0, s57, 18432
  s_nop 0
  buffer_load_dwordx4 v6, s[32:35], s61 offen offset:1024 sc1 lds
  s_add_u32 s60, s84, 28672
  s_add_u32 s61, s84, 57344
  s_add_u32 m0, s57, 0
  s_nop 0
  buffer_load_dwordx4 v6, s[32:35], s60 offen sc1 lds
  s_add_u32 m0, s57, 0
  s_nop 0
  buffer_load_dwordx4 v6, s[32:35], s60 offen offset:1024 sc1 lds
  s_add_u32 m0, s57, 2048
  s_nop 0
  buffer_load_dwordx4 v6, s[32:35], s61 offen sc1 lds
  s_add_u32 m0, s57, 2048
  s_nop 0
  buffer_load_dwordx4 v6, s[32:35], s61 offen offset:1024 sc1 lds
  s_branch Lfetch_val
Lfetch_done:
  s_branch Lp2b
Lp2:
  s_mul_i32 s64, s37, 7
  s_lshr_b32 s64, s64, 1
  v_add_u32 v21, s64, v5
  v_and_b32 v21, 1, v21
  v_mul_u32_u24 v21, 12, v21
  v_bfe_u32 v22, v4, 1, 1
  v_add_u32 v23, s64, v22
  v_and_b32 v23, 1, v23
  v_mul_u32_u24 v23, 12, v23
  s_add_u32 s60, s38, 0
  s_lshr_b32 s61, s60, 1
  s_lshl_b32 s61, s61, 12
  s_and_b32 s60, s60, 1
  s_lshl_b32 s60, s60, 4
  v_add_u32 v18, s60, v4
  v_xor_b32 v18, v18, v21
  v_lshlrev_b32 v18, 4, v18
  v_lshl_add_u32 v18, v5, 9, v18
  v_add_u32 v180, s61, v18
  s_lshr_b32 s62, s61, 1
  s_add_u32 s62, s62, 49152
  v_add_u32 v186, s62, v18
  v_lshrrev_b32 v18, 2, v4
  v_lshl_add_u32 v18, v5, 2, v18
  v_add_u32 v18, s60, v18
  v_xor_b32 v18, v18, v23
  v_lshlrev_b32 v18, 4, v18
  v_lshl_add_u32 v18, v22, 9, v18
  v_and_b32 v19, 1, v4
  v_lshl_add_u32 v18, v19, 3, v18
  v_add_u32 v184, s61, v18
  s_add_u32 s60, s38, 1
  s_lshr_b32 s61, s60, 1
  s_lshl_b32 s61, s61, 12
  s_and_b32 s60, s60, 1
  s_lshl_b32 s60, s60, 4
  v_add_u32 v18, s60, v4
  v_xor_b32 v18, v18, v21
  v_lshlrev_b32 v18, 4, v18
  v_lshl_add_u32 v18, v5, 9, v18
  v_add_u32 v181, s61, v18
  v_lshrrev_b32 v18, 2, v4
  v_lshl_add_u32 v18, v5, 2, v18
  v_add_u32 v18, s60, v18
  v_xor_b32 v18, v18, v23
  v_lshlrev_b32 v18, 4, v18
  v_lshl_add_u32 v18, v22, 9, v18
  v_and_b32 v19, 1, v4
  v_lshl_add_u32 v18, v19, 3, v18
  v_add_u32 v185, s61, v18
  s_and_b32 s60, s37, 1
  s_cmp_eq_u32 s60, 0
  s_cselect_b32 s80, 0, 0xffff
  s_mov_b32 s81, 0
  s_mov_b32 s82, 0
  s_cselect_b32 s83, 0xffff0000, 0
  v_mov_b32 v200, 0x3f803f80
  v_mov_b32 v201, 0x3f803f80
  v_mov_b32 v202, 0x3f803f80
  v_mov_b32 v203, 0x3f803f80
  v_mov_b32 v188, 0xf149f2ca
  v_lshlrev_b32 v18, 2, v5
  v_sub_u32 v18, v18, v4
  v_cmp_lt_i32 vcc, 0, v18
  s_nop 1
  v_cndmask_b32 v128, v188, v24, vcc
  v_cndmask_b32 v132, v24, v188, vcc
  v_cmp_lt_i32 vcc, -1, v18
  s_nop 1
  v_cndmask_b32 v129, v188, v24, vcc
  v_cndmask_b32 v133, v24, v188, vcc
  v_cmp_lt_i32 vcc, -2, v18
  s_nop 1
  v_cndmask_b32 v130, v188, v24, vcc
  v_cndmask_b32 v134, v24, v188, vcc
  v_cmp_lt_i32 vcc, -3, v18
  s_nop 1
  v_cndmask_b32 v131, v188, v24, vcc
  v_cndmask_b32 v135, v24, v188, vcc
  s_lshl_b32 s60, s36, 9
  s_add_u32 s60, s60, 17825792
  v_lshlrev_b32 v189, 3, v4
  v_add_u32 v189, s60, v189
  s_lshr_b32 s61, s38, 1
  s_and_b32 s62, s38, 1
  s_lshl_b32 s78, s36, 17
  s_lshl_b32 s65, s61, 15
  s_add_u32 s78, s78, s65
  s_lshl_b32 s65, s37, 11
  s_add_u32 s78, s78, s65
  s_lshl_b32 s65, s62, 8
  s_add_u32 s78, s78, s65
  s_add_u32 s78, s78, 6291456
  s_lshl_b32 s79, s36, 10
  s_lshl_b32 s65, s38, 7
  s_add_u32 s79, s79, s65
  s_lshl_b32 s65, s37, 3
  s_add_u32 s79, s79, s65
  s_add_u32 s79, s79, 17891328
  v_lshlrev_b32 v192, 9, v5
  v_lshl_add_u32 v192, v4, 4, v192
  v_mov_b32 v146, 0
  v_mov_b32 v147, 0
  s_nop 2
Lp2b:
  s_barrier
  s_cmp_lt_u32 s38, 4
  s_cbranch_scc1 Lp2go
  s_add_u32 s60, s45, 8
  s_mul_i32 s61, s60, 114688
  s_mul_i32 s62, s45, 7168
  s_add_u32 m0, s62, 57344
  s_nop 0
  buffer_load_dwordx4 v241, s[16:19], s61 offen lds
  s_add_u32 m0, s62, 58368
  s_nop 0
  buffer_load_dwordx4 v242, s[16:19], s61 offen lds
  s_add_u32 m0, s62, 59392
  s_nop 0
  buffer_load_dwordx4 v243, s[16:19], s61 offen lds
  s_add_u32 m0, s62, 60416
  s_nop 0
  buffer_load_dwordx4 v244, s[16:19], s61 offen lds
  s_add_u32 m0, s62, 61440
  s_nop 0
  buffer_load_dwordx4 v245, s[16:19], s61 offen lds
  s_add_u32 m0, s62, 62464
  s_nop 0
  buffer_load_dwordx4 v246, s[16:19], s61 offen lds
  s_add_u32 m0, s62, 63488
  s_nop 0
  buffer_load_dwordx4 v247, s[16:19], s61 offen lds
  s_mul_i32 s60, s59, 28672
  s_mul_i32 s65, s45, 7168
  s_add_u32 s60, s60, s65
  v_min_u32 v18, 7040, v248
  buffer_load_dword v26, v18, s[16:19], s60 offen
  s_nop 1
Lp2go:
  buffer_load_dwordx2 v[190:191], v189, s[32:35], 0 offen sc1
  ds_read_b128 v[124:127], v186
  ds_read_b128 v[100:103], v180 offset:0
  ds_read_b128 v[104:107], v181 offset:0
  ds_read_b128 v[108:111], v180 offset:4096
  ds_read_b128 v[112:115], v181 offset:4096
  ds_read_b128 v[116:119], v180 offset:8192
  ds_read_b128 v[120:123], v181 offset:8192
  s_waitcnt lgkmcnt(5)
  v_cndmask_b32 v124, v124, v24, s[80:81]
  v_cndmask_b32 v126, v126, v24, s[82:83]
  v_cndmask_b32 v125, v125, v24, s[80:81]
  v_cndmask_b32 v127, v127, v24, s[82:83]
  s_nop 1
  v_mfma_f32_16x16x32_bf16 v[32:35], v[100:103], v[124:127], v[128:131]
  ds_read_b128 v[100:103], v180 offset:12288
  s_waitcnt lgkmcnt(5)
  v_mfma_f32_16x16x32_bf16 v[36:39], v[104:107], v[124:127], 0
  ds_read_b128 v[104:107], v181 offset:12288
  s_waitcnt lgkmcnt(5)
  v_mfma_f32_16x16x32_bf16 v[40:43], v[108:111], v[124:127], 0
  ds_read_b128 v[108:111], v180 offset:16384
  s_waitcnt lgkmcnt(5)
  v_mfma_f32_16x16x32_bf16 v[44:47], v[112:115], v[124:127], 0
  ds_read_b128 v[112:115], v181 offset:16384
  s_waitcnt lgkmcnt(5)
  v_mfma_f32_16x16x32_bf16 v[48:51], v[116:119], v[124:127], 0
  ds_read_b128 v[116:119], v180 offset:20480
  s_waitcnt lgkmcnt(5)
  v_mfma_f32_16x16x32_bf16 v[52:55], v[120:123], v[124:127], 0
  ds_read_b128 v[120:123], v181 offset:20480
  s_waitcnt lgkmcnt(5)
  v_mfma_f32_16x16x32_bf16 v[56:59], v[100:103], v[124:127], 0
  ds_read_b128 v[100:103], v180 offset:24576
  s_waitcnt lgkmcnt(5)
  v_mfma_f32_16x16x32_bf16 v[60:63], v[104:107], v[124:127], 0
  ds_read_b128 v[104:107], v181 offset:24576
  s_waitcnt lgkmcnt(5)
  v_mfma_f32_16x16x32_bf16 v[64:67], v[108:111], v[124:127], 0
  ds_read_b128 v[108:111], v180 offset:28672
  s_waitcnt lgkmcnt(5)
  v_mfma_f32_16x16x32_bf16 v[68:71], v[112:115], v[124:127], 0
  ds_read_b128 v[112:115], v181 offset:28672
  s_waitcnt lgkmcnt(5)
  v_mfma_f32_16x16x32_bf16 v[72:75], v[116:119], v[124:127], 0
  ds_read_b128 v[116:119], v180 offset:32768
  s_waitcnt lgkmcnt(5)
  v_mfma_f32_16x16x32_bf16 v[76:79], v[120:123], v[124:127], 0
  s_waitcnt lgkmcnt(4)
  v_mfma_f32_16x16x32_bf16 v[80:83], v[100:103], v[124:127], 0
  s_waitcnt lgkmcnt(3)
  v_mfma_f32_16x16x32_bf16 v[84:87], v[104:107], v[124:127], 0
  s_waitcnt lgkmcnt(2)
  v_mfma_f32_16x16x32_bf16 v[88:91], v[108:111], v[124:127], 0
  s_waitcnt lgkmcnt(1)
  v_mfma_f32_16x16x32_bf16 v[92:95], v[112:115], v[124:127], 0
  s_waitcnt lgkmcnt(0)
  v_mfma_f32_16x16x32_bf16 v[96:99], v[116:119], v[124:127], v[132:135]
  ds_read_b64_tr_b16 v[148:149], v184 offset:2048
  ds_read_b64_tr_b16 v[150:151], v185 offset:2048
  ds_read_b64_tr_b16 v[152:153], v184 offset:3072
  ds_read_b64_tr_b16 v[154:155], v185 offset:3072
  ds_read_b64_tr_b16 v[156:157], v184 offset:6144
  ds_read_b64_tr_b16 v[158:159], v185 offset:6144
  ds_read_b64_tr_b16 v[160:161], v184 offset:7168
  ds_read_b64_tr_b16 v[162:163], v185 offset:7168
  ds_read_b64_tr_b16 v[164:165], v184 offset:10240
  ds_read_b64_tr_b16 v[166:167], v185 offset:10240
  ds_read_b64_tr_b16 v[168:169], v184 offset:11264
  ds_read_b64_tr_b16 v[170:171], v185 offset:11264
  s_cmp_ge_u32 s36, 2
  s_cbranch_scc1 Lnoinv
  s_lshl_b32 s60, s36, 3
  s_add_u32 s60, s60, s38
  s_sub_u32 s60, 16, s60
  s_cmp_le_u32 s60, 0
  s_cbranch_scc1 Lnoinv
  v_mov_b32 v32, v188
  v_mov_b32 v33, v188
  v_mov_b32 v34, v188
  v_mov_b32 v35, v188
  s_cmp_le_u32 s60, 1
  s_nop 1
  s_cbranch_scc1 Lnoinv
  v_mov_b32 v36, v188
  v_mov_b32 v37, v188
  v_mov_b32 v38, v188
  v_mov_b32 v39, v188
  s_cmp_le_u32 s60, 2
  s_nop 1
  s_cbranch_scc1 Lnoinv
  v_mov_b32 v40, v188
  v_mov_b32 v41, v188
  v_mov_b32 v42, v188
  v_mov_b32 v43, v188
  s_cmp_le_u32 s60, 3
  s_nop 1
  s_cbranch_scc1 Lnoinv
  v_mov_b32 v44, v188
  v_mov_b32 v45, v188
  v_mov_b32 v46, v188
  v_mov_b32 v47, v188
  s_cmp_le_u32 s60, 4
  s_nop 1
  s_cbranch_scc1 Lnoinv
  v_mov_b32 v48, v188
  v_mov_b32 v49, v188
  v_mov_b32 v50, v188
  v_mov_b32 v51, v188
  s_cmp_le_u32 s60, 5
  s_nop 1
  s_cbranch_scc1 Lnoinv
  v_mov_b32 v52, v188
  v_mov_b32 v53, v188
  v_mov_b32 v54, v188
  v_mov_b32 v55, v188
  s_cmp_le_u32 s60, 6
  s_nop 1
  s_cbranch_scc1 Lnoinv
  v_mov_b32 v56, v188
  v_mov_b32 v57, v188
  v_mov_b32 v58, v188
  v_mov_b32 v59, v188
  s_cmp_le_u32 s60, 7
  s_nop 1
  s_cbranch_scc1 Lnoinv
  v_mov_b32 v60, v188
  v_mov_b32 v61, v188
  v_mov_b32 v62, v188
  v_mov_b32 v63, v188
  s_cmp_le_u32 s60, 8
  s_nop 1
  s_cbranch_scc1 Lnoinv
  v_mov_b32 v64, v188
  v_mov_b32 v65, v188
  v_mov_b32 v66, v188
  v_mov_b32 v67, v188
  s_cmp_le_u32 s60, 9
  s_nop 1
  s_cbranch_scc1 Lnoinv
  v_mov_b32 v68, v188
  v_mov_b32 v69, v188
  v_mov_b32 v70, v188
  v_mov_b32 v71, v188
  s_cmp_le_u32 s60, 10
  s_nop 1
  s_cbranch_scc1 Lnoinv
  v_mov_b32 v72, v188
  v_mov_b32 v73, v188
  v_mov_b32 v74, v188
  v_mov_b32 v75, v188
  s_cmp_le_u32 s60, 11
  s_nop 1
  s_cbranch_scc1 Lnoinv
  v_mov_b32 v76, v188
  v_mov_b32 v77, v188
  v_mov_b32 v78, v188
  v_mov_b32 v79, v188
  s_cmp_le_u32 s60, 12
  s_nop 1
  s_cbranch_scc1 Lnoinv
  v_mov_b32 v80, v188
  v_mov_b32 v81, v188
  v_mov_b32 v82, v188
  v_mov_b32 v83, v188
  s_cmp_le_u32 s60, 13
  s_nop 1
  s_cbranch_scc1 Lnoinv
  v_mov_b32 v84, v188
  v_mov_b32 v85, v188
  v_mov_b32 v86, v188
  v_mov_b32 v87, v188
  s_cmp_le_u32 s60, 14
  s_nop 1
  s_cbranch_scc1 Lnoinv
  v_mov_b32 v88, v188
  v_mov_b32 v89, v188
  v_mov_b32 v90, v188
  v_mov_b32 v91, v188
  s_cmp_le_u32 s60, 15
  s_nop 1
  s_cbranch_scc1 Lnoinv
  v_mov_b32 v92, v188
  v_mov_b32 v93, v188
  v_mov_b32 v94, v188
  v_mov_b32 v95, v188
  s_nop 2
Lnoinv:
  v_max3_f32 v18, v32, v33, v34
  v_max3_f32 v19, v35, v36, v37
  v_max3_f32 v18, v18, v38, v39
  v_max3_f32 v19, v19, v40, v41
  v_max3_f32 v18, v18, v42, v43
  v_max3_f32 v19, v19, v44, v45
  v_max3_f32 v18, v18, v46, v47
  v_max3_f32 v19, v19, v48, v49
  v_max3_f32 v18, v18, v50, v51
  v_max3_f32 v19, v19, v52, v53
  v_max3_f32 v18, v18, v54, v55
  v_max3_f32 v19, v19, v56, v57
  v_max3_f32 v18, v18, v58, v59
  v_max3_f32 v19, v19, v60, v61
  v_max3_f32 v18, v18, v62, v63
  v_max3_f32 v19, v19, v64, v65
  v_max3_f32 v18, v18, v66, v67
  v_max3_f32 v19, v19, v68, v69
  v_max3_f32 v18, v18, v70, v71
  v_max3_f32 v19, v19, v72, v73
  v_max3_f32 v18, v18, v74, v75
  v_max3_f32 v19, v19, v76, v77
  v_max3_f32 v18, v18, v78, v79
  v_max3_f32 v19, v19, v80, v81
  v_max3_f32 v18, v18, v82, v83
  v_max3_f32 v19, v19, v84, v85
  v_max3_f32 v18, v18, v86, v87
  v_max3_f32 v19, v19, v88, v89
  v_max3_f32 v18, v18, v90, v91
  v_max3_f32 v19, v19, v92, v93
  v_max3_f32 v18, v18, v94, v95
  v_max3_f32 v19, v19, v96, v97
  v_max3_f32 v18, v18, v98, v99
  v_max_f32 v18, v18, v19
  v_mov_b32 v19, v18
  s_nop 1
  v_permlane32_swap_b32 v18, v19
  v_max_f32 v18, v18, v19
  v_mov_b32 v19, v18
  s_nop 1
  v_permlane16_swap_b32 v18, v19
  v_max_f32 v18, v18, v19
  s_mov_b32 s60, 0x3e8b97f6
  v_mul_f32 v18, 0xbe8b97f6, v18
  v_fma_f32 v32, v32, s60, v18
  v_fma_f32 v33, v33, s60, v18
  v_fma_f32 v34, v34, s60, v18
  v_fma_f32 v35, v35, s60, v18
  v_fma_f32 v36, v36, s60, v18
  v_fma_f32 v37, v37, s60, v18
  v_fma_f32 v38, v38, s60, v18
  v_fma_f32 v39, v39, s60, v18
  v_exp_f32 v32, v32
  v_exp_f32 v33, v33
  v_exp_f32 v34, v34
  v_exp_f32 v35, v35
  v_exp_f32 v36, v36
  v_exp_f32 v37, v37
  v_exp_f32 v38, v38
  v_exp_f32 v39, v39
  v_cvt_pk_bf16_f32 v136, v32, v33
  v_cvt_pk_bf16_f32 v137, v34, v35
  v_cvt_pk_bf16_f32 v138, v36, v37
  v_cvt_pk_bf16_f32 v139, v38, v39
  s_nop 1
  v_mfma_f32_16x16x32_bf16 v[196:199], v[200:203], v[136:139], 0
  s_waitcnt lgkmcnt(10)
  v_mfma_f32_16x16x32_bf16 v[172:175], v[148:151], v[136:139], 0
  ds_read_b64_tr_b16 v[148:149], v184 offset:14336
  ds_read_b64_tr_b16 v[150:151], v185 offset:14336
  s_waitcnt lgkmcnt(10)
  v_mfma_f32_16x16x32_bf16 v[176:179], v[152:155], v[136:139], 0
  ds_read_b64_tr_b16 v[152:153], v184 offset:15360
  ds_read_b64_tr_b16 v[154:155], v185 offset:15360
  v_fma_f32 v40, v40, s60, v18
  v_fma_f32 v41, v41, s60, v18
  v_fma_f32 v42, v42, s60, v18
  v_fma_f32 v43, v43, s60, v18
  v_fma_f32 v44, v44, s60, v18
  v_fma_f32 v45, v45, s60, v18
  v_fma_f32 v46, v46, s60, v18
  v_fma_f32 v47, v47, s60, v18
  v_exp_f32 v40, v40
  v_exp_f32 v41, v41
  v_exp_f32 v42, v42
  v_exp_f32 v43, v43
  v_exp_f32 v44, v44
  v_exp_f32 v45, v45
  v_exp_f32 v46, v46
  v_exp_f32 v47, v47
  v_cvt_pk_bf16_f32 v140, v40, v41
  v_cvt_pk_bf16_f32 v141, v42, v43
  v_cvt_pk_bf16_f32 v142, v44, v45
  v_cvt_pk_bf16_f32 v143, v46, v47
  s_nop 1
  v_mfma_f32_16x16x32_bf16 v[196:199], v[200:203], v[140:143], v[196:199]
  s_waitcnt lgkmcnt(10)
  v_mfma_f32_16x16x32_bf16 v[172:175], v[156:159], v[140:143], v[172:175]
  ds_read_b64_tr_b16 v[156:157], v184 offset:18432
  ds_read_b64_tr_b16 v[158:159], v185 offset:18432
  s_waitcnt lgkmcnt(10)
  v_mfma_f32_16x16x32_bf16 v[176:179], v[160:163], v[140:143], v[176:179]
  ds_read_b64_tr_b16 v[160:161], v184 offset:19456
  ds_read_b64_tr_b16 v[162:163], v185 offset:19456
  v_fma_f32 v48, v48, s60, v18
  v_fma_f32 v49, v49, s60, v18
  v_fma_f32 v50, v50, s60, v18
  v_fma_f32 v51, v51, s60, v18
  v_fma_f32 v52, v52, s60, v18
  v_fma_f32 v53, v53, s60, v18
  v_fma_f32 v54, v54, s60, v18
  v_fma_f32 v55, v55, s60, v18
  v_exp_f32 v48, v48
  v_exp_f32 v49, v49
  v_exp_f32 v50, v50
  v_exp_f32 v51, v51
  v_exp_f32 v52, v52
  v_exp_f32 v53, v53
  v_exp_f32 v54, v54
  v_exp_f32 v55, v55
  v_cvt_pk_bf16_f32 v136, v48, v49
  v_cvt_pk_bf16_f32 v137, v50, v51
  v_cvt_pk_bf16_f32 v138, v52, v53
  v_cvt_pk_bf16_f32 v139, v54, v55
  s_nop 1
  v_mfma_f32_16x16x32_bf16 v[196:199], v[200:203], v[136:139], v[196:199]
  s_waitcnt lgkmcnt(10)
  v_mfma_f32_16x16x32_bf16 v[172:175], v[164:167], v[136:139], v[172:175]
  ds_read_b64_tr_b16 v[164:165], v184 offset:22528
  ds_read_b64_tr_b16 v[166:167], v185 offset:22528
  s_waitcnt lgkmcnt(10)
  v_mfma_f32_16x16x32_bf16 v[176:179], v[168:171], v[136:139], v[176:179]
  ds_read_b64_tr_b16 v[168:169], v184 offset:23552
  ds_read_b64_tr_b16 v[170:171], v185 offset:23552
  v_fma_f32 v56, v56, s60, v18
  v_fma_f32 v57, v57, s60, v18
  v_fma_f32 v58, v58, s60, v18
  v_fma_f32 v59, v59, s60, v18
  v_fma_f32 v60, v60, s60, v18
  v_fma_f32 v61, v61, s60, v18
  v_fma_f32 v62, v62, s60, v18
  v_fma_f32 v63, v63, s60, v18
  v_exp_f32 v56, v56
  v_exp_f32 v57, v57
  v_exp_f32 v58, v58
  v_exp_f32 v59, v59
  v_exp_f32 v60, v60
  v_exp_f32 v61, v61
  v_exp_f32 v62, v62
  v_exp_f32 v63, v63
  v_cvt_pk_bf16_f32 v140, v56, v57
  v_cvt_pk_bf16_f32 v141, v58, v59
  v_cvt_pk_bf16_f32 v142, v60, v61
  v_cvt_pk_bf16_f32 v143, v62, v63
  s_nop 1
  v_mfma_f32_16x16x32_bf16 v[196:199], v[200:203], v[140:143], v[196:199]
  s_waitcnt lgkmcnt(10)
  v_mfma_f32_16x16x32_bf16 v[172:175], v[148:151], v[140:143], v[172:175]
  ds_read_b64_tr_b16 v[148:149], v184 offset:26624
  ds_read_b64_tr_b16 v[150:151], v185 offset:26624
  s_waitcnt lgkmcnt(10)
  v_mfma_f32_16x16x32_bf16 v[176:179], v[152:155], v[140:143], v[176:179]
  ds_read_b64_tr_b16 v[152:153], v184 offset:27648
  ds_read_b64_tr_b16 v[154:155], v185 offset:27648
  v_fma_f32 v64, v64, s60, v18
  v_fma_f32 v65, v65, s60, v18
  v_fma_f32 v66, v66, s60, v18
  v_fma_f32 v67, v67, s60, v18
  v_fma_f32 v68, v68, s60, v18
  v_fma_f32 v69, v69, s60, v18
  v_fma_f32 v70, v70, s60, v18
  v_fma_f32 v71, v71, s60, v18
  v_exp_f32 v64, v64
  v_exp_f32 v65, v65
  v_exp_f32 v66, v66
  v_exp_f32 v67, v67
  v_exp_f32 v68, v68
  v_exp_f32 v69, v69
  v_exp_f32 v70, v70
  v_exp_f32 v71, v71
  v_cvt_pk_bf16_f32 v136, v64, v65
  v_cvt_pk_bf16_f32 v137, v66, v67
  v_cvt_pk_bf16_f32 v138, v68, v69
  v_cvt_pk_bf16_f32 v139, v70, v71
  s_nop 1
  v_mfma_f32_16x16x32_bf16 v[196:199], v[200:203], v[136:139], v[196:199]
  s_waitcnt lgkmcnt(10)
  v_mfma_f32_16x16x32_bf16 v[172:175], v[156:159], v[136:139], v[172:175]
  ds_read_b64_tr_b16 v[156:157], v184 offset:30720
  ds_read_b64_tr_b16 v[158:159], v185 offset:30720
  s_waitcnt lgkmcnt(10)
  v_mfma_f32_16x16x32_bf16 v[176:179], v[160:163], v[136:139], v[176:179]
  ds_read_b64_tr_b16 v[160:161], v184 offset:31744
  ds_read_b64_tr_b16 v[162:163], v185 offset:31744
  v_fma_f32 v72, v72, s60, v18
  v_fma_f32 v73, v73, s60, v18
  v_fma_f32 v74, v74, s60, v18
  v_fma_f32 v75, v75, s60, v18
  v_fma_f32 v76, v76, s60, v18
  v_fma_f32 v77, v77, s60, v18
  v_fma_f32 v78, v78, s60, v18
  v_fma_f32 v79, v79, s60, v18
  v_exp_f32 v72, v72
  v_exp_f32 v73, v73
  v_exp_f32 v74, v74
  v_exp_f32 v75, v75
  v_exp_f32 v76, v76
  v_exp_f32 v77, v77
  v_exp_f32 v78, v78
  v_exp_f32 v79, v79
  v_cvt_pk_bf16_f32 v140, v72, v73
  v_cvt_pk_bf16_f32 v141, v74, v75
  v_cvt_pk_bf16_f32 v142, v76, v77
  v_cvt_pk_bf16_f32 v143, v78, v79
  s_nop 1
  v_mfma_f32_16x16x32_bf16 v[196:199], v[200:203], v[140:143], v[196:199]
  s_waitcnt lgkmcnt(10)
  v_mfma_f32_16x16x32_bf16 v[172:175], v[164:167], v[140:143], v[172:175]
  ds_read_b64_tr_b16 v[164:165], v184 offset:34816
  ds_read_b64_tr_b16 v[166:167], v184 offset:34816
  s_waitcnt lgkmcnt(10)
  v_mfma_f32_16x16x32_bf16 v[176:179], v[168:171], v[140:143], v[176:179]
  ds_read_b64_tr_b16 v[168:169], v184 offset:35840
  ds_read_b64_tr_b16 v[170:171], v184 offset:35840
  v_fma_f32 v80, v80, s60, v18
  v_fma_f32 v81, v81, s60, v18
  v_fma_f32 v82, v82, s60, v18
  v_fma_f32 v83, v83, s60, v18
  v_fma_f32 v84, v84, s60, v18
  v_fma_f32 v85, v85, s60, v18
  v_fma_f32 v86, v86, s60, v18
  v_fma_f32 v87, v87, s60, v18
  v_exp_f32 v80, v80
  v_exp_f32 v81, v81
  v_exp_f32 v82, v82
  v_exp_f32 v83, v83
  v_exp_f32 v84, v84
  v_exp_f32 v85, v85
  v_exp_f32 v86, v86
  v_exp_f32 v87, v87
  v_cvt_pk_bf16_f32 v136, v80, v81
  v_cvt_pk_bf16_f32 v137, v82, v83
  v_cvt_pk_bf16_f32 v138, v84, v85
  v_cvt_pk_bf16_f32 v139, v86, v87
  s_nop 1
  v_mfma_f32_16x16x32_bf16 v[196:199], v[200:203], v[136:139], v[196:199]
  s_waitcnt lgkmcnt(10)
  v_mfma_f32_16x16x32_bf16 v[172:175], v[148:151], v[136:139], v[172:175]
  s_waitcnt lgkmcnt(8)
  v_mfma_f32_16x16x32_bf16 v[176:179], v[152:155], v[136:139], v[176:179]
  s_waitcnt vmcnt(0)
  v_and_b32 v22, -8, v190
  v_mov_b32 v23, v191
  v_cmp_ne_u64 vcc, s[42:43], v[22:23]
  s_nop 4
  s_cbranch_vccz Lgf_ok
  s_mov_b32 s58, 0x20000
Lpoll_gf_10:
  buffer_load_dwordx2 v[22:23], v189, s[32:35], 0 offen sc1
  s_sub_u32 s58, s58, 1
  s_waitcnt vmcnt(0)
  v_and_b32 v22, -8, v22
  v_cmp_ne_u64 vcc, s[42:43], v[22:23]
  s_cmp_eq_u32 s58, 0
  s_nop 3
  s_cbranch_scc1 Lpolld_gf_11
  s_cbranch_vccnz Lpoll_gf_10
Lpolld_gf_11:
  buffer_load_dwordx2 v[190:191], v189, s[32:35], 0 offen sc1
  s_waitcnt vmcnt(0)
Lgf_ok:
  v_cmp_ne_u32 vcc, v190, v16
  s_nop 1
  s_cmp_eq_u64 vcc, 0
  s_cselect_b32 s41, 1, 0
  v_fma_f32 v88, v88, s60, v18
  v_fma_f32 v89, v89, s60, v18
  v_fma_f32 v90, v90, s60, v18
  v_fma_f32 v91, v91, s60, v18
  v_fma_f32 v92, v92, s60, v18
  v_fma_f32 v93, v93, s60, v18
  v_fma_f32 v94, v94, s60, v18
  v_fma_f32 v95, v95, s60, v18
  v_exp_f32 v88, v88
  v_exp_f32 v89, v89
  v_exp_f32 v90, v90
  v_exp_f32 v91, v91
  v_exp_f32 v92, v92
  v_exp_f32 v93, v93
  v_exp_f32 v94, v94
  v_exp_f32 v95, v95
  v_cvt_pk_bf16_f32 v140, v88, v89
  v_cvt_pk_bf16_f32 v141, v90, v91
  v_cvt_pk_bf16_f32 v142, v92, v93
  v_cvt_pk_bf16_f32 v143, v94, v95
  s_nop 1
  v_mfma_f32_16x16x32_bf16 v[196:199], v[200:203], v[140:143], v[196:199]
  s_waitcnt lgkmcnt(6)
  v_mfma_f32_16x16x32_bf16 v[172:175], v[156:159], v[140:143], v[172:175]
  s_waitcnt lgkmcnt(4)
  v_mfma_f32_16x16x32_bf16 v[176:179], v[160:163], v[140:143], v[176:179]
  v_fma_f32 v96, v96, s60, v18
  v_fma_f32 v97, v97, s60, v18
  v_fma_f32 v98, v98, s60, v18
  v_fma_f32 v99, v99, s60, v18
  v_exp_f32 v96, v96
  v_exp_f32 v97, v97
  v_exp_f32 v98, v98
  v_exp_f32 v99, v99
  v_cvt_pk_bf16_f32 v144, v96, v97
  v_cvt_pk_bf16_f32 v145, v98, v99
  s_nop 1
  v_mfma_f32_16x16x32_bf16 v[196:199], v[200:203], v[144:147], v[196:199]
  s_waitcnt lgkmcnt(2)
  v_mfma_f32_16x16x32_bf16 v[172:175], v[164:167], v[144:147], v[172:175]
  s_waitcnt lgkmcnt(0)
  v_mfma_f32_16x16x32_bf16 v[176:179], v[168:171], v[144:147], v[176:179]
  s_nop 3
  v_rcp_f32 v20, v196
  s_nop 0
  v_cndmask_b32 v18, v20, v24, s[80:81]
  v_cndmask_b32 v19, v20, v24, s[82:83]
  v_mul_f32 v172, v172, v18
  v_mul_f32 v176, v176, v19
  v_mul_f32 v173, v173, v18
  v_mul_f32 v177, v177, v19
  v_mul_f32 v174, v174, v18
  v_mul_f32 v178, v178, v19
  v_mul_f32 v175, v175, v18
  v_mul_f32 v179, v179, v19
  v_cvt_pk_bf16_f32 v136, v172, v173
  v_cvt_pk_bf16_f32 v137, v174, v175
  v_cvt_pk_bf16_f32 v138, v176, v177
  v_cvt_pk_bf16_f32 v139, v178, v179
  s_cmp_eq_u32 s41, 0
  s_nop 1
  s_cbranch_scc1 Lslow_12
  buffer_store_dwordx4 v[136:139], v192, s[32:35], s78 offen
  s_waitcnt vmcnt(0)
  s_mov_b64 exec, 1
  buffer_store_dwordx2 v[16:17], v24, s[32:35], s79 offen
  s_mov_b64 exec, -1
  s_branch Lpub_13
Lslow_12:
  buffer_store_dwordx4 v[136:139], v192, s[32:35], s78 offen sc1
  s_waitcnt vmcnt(0)
  s_mov_b64 exec, 1
  buffer_store_dwordx2 v[16:17], v24, s[32:35], s79 offen sc1
  s_mov_b64 exec, -1
Lpub_13:
  s_cmp_ge_u32 s38, 4
  s_cbranch_scc1 Lhelper2
  s_cmp_ge_u32 s37, 14
  s_cbranch_scc1 Lp3_idle
  s_mul_i32 s60, s48, 28672
  v_lshrrev_b32 v18, 2, v4
  v_lshrrev_b32 v19, 1, v18
  v_xor_b32 v19, s48, v19
  v_lshl_add_u32 v18, v3, 2, v18
  v_lshlrev_b32 v18, 7, v18
  v_bfe_u32 v20, v1, 4, 1
  v_lshl_add_u32 v18, v20, 5, v18
  v_and_b32 v20, 3, v1
  v_lshl_add_u32 v18, v20, 3, v18
  v_add_u32 v18, s60, v18
  v_add_u32 v18, 86016, v18
  v_lshl_add_u32 v160, v19, 6, v18
  v_xor_b32 v161, 64, v160
  v_add_u32 v162, s57, v6
  v_xor_b32 v163, 0x2000, v162
  v_add_u32 v162, 144384, v162
  v_add_u32 v163, 144384, v163
  s_lshl_b32 s60, s36, 10
  s_lshl_b32 s65, s46, 9
  s_add_u32 s60, s60, s65
  s_lshl_b32 s65, s49, 8
  s_add_u32 s60, s60, s65
  s_lshl_b32 s65, s48, 6
  s_add_u32 s60, s60, s65
  s_add_u32 s60, s60, 17891328
  v_bfe_u32 v18, v1, 3, 1
  v_lshlrev_b32 v18, 7, v18
  v_and_b32 v19, 7, v1
  v_lshl_add_u32 v18, v19, 3, v18
  v_add_u32 v166, s60, v18
  s_lshl_b32 s64, s72, 15
  s_lshl_b32 s65, s48, 14
  s_add_u32 s64, s64, s65
  s_add_u32 s64, s64, 6291456
  s_mul_i32 s74, s72, 86016
  s_lshl_b32 s65, s47, 11
  s_add_u32 s74, s74, s65
  s_lshl_b32 s65, s48, 10
  s_add_u32 s74, s74, s65
  s_lshl_b32 s75, s72, 12
  s_lshl_b32 s65, s47, 9
  s_add_u32 s75, s75, s65
  s_lshl_b32 s65, s48, 8
  s_add_u32 s75, s75, s65
  s_add_u32 s75, s75, 18087936
  s_lshl_b32 s76, s72, 7
  s_lshl_b32 s65, s47, 4
  s_add_u32 s76, s76, s65
  s_lshl_b32 s65, s48, 3
  s_add_u32 s76, s76, s65
  s_add_u32 s76, s76, 17956864
  v_bfe_u32 v18, v1, 4, 1
  v_mul_u32_u24 v18, 14336, v18
  v_lshl_add_u32 v18, v3, 8, v18
  v_lshl_add_u32 v164, v4, 4, v18
  v_lshlrev_b32 v165, 3, v2
  v_lshlrev_b32 v168, 16, v8
  v_and_b32 v169, 0xffff0000, v8
  v_lshlrev_b32 v170, 16, v9
  v_and_b32 v171, 0xffff0000, v9
  v_lshlrev_b32 v172, 16, v10
  v_and_b32 v173, 0xffff0000, v10
  v_lshlrev_b32 v174, 16, v11
  v_and_b32 v175, 0xffff0000, v11
  v_lshlrev_b32 v176, 16, v12
  v_and_b32 v177, 0xffff0000, v12
  v_lshlrev_b32 v178, 16, v13
  v_and_b32 v179, 0xffff0000, v13
  v_lshlrev_b32 v180, 16, v14
  v_and_b32 v181, 0xffff0000, v14
  v_lshlrev_b32 v182, 16, v15
  v_and_b32 v183, 0xffff0000, v15
  v_mov_b32 v167, 0x3f803f80
  s_barrier
  ds_read_b64_tr_b16 v[128:129], v160 offset:0
  ds_read_b64_tr_b16 v[130:131], v160 offset:2048
  ds_read_b64_tr_b16 v[132:133], v161 offset:0
  ds_read_b64_tr_b16 v[134:135], v161 offset:2048
  ds_read_b64_tr_b16 v[136:137], v160 offset:1024
  ds_read_b64_tr_b16 v[138:139], v160 offset:3072
  ds_read_b64_tr_b16 v[140:141], v161 offset:1024
  ds_read_b64_tr_b16 v[142:143], v161 offset:3072
  ds_read_b64_tr_b16 v[144:145], v160 offset:3072
  ds_read_b64_tr_b16 v[146:147], v160 offset:5120
  ds_read_b64_tr_b16 v[148:149], v161 offset:3072
  ds_read_b64_tr_b16 v[150:151], v161 offset:5120
  s_mov_b32 s58, 0x20000
Lpoll_f2_14:
  buffer_load_dwordx2 v[20:21], v166, s[32:35], 0 offen sc1
  s_sub_u32 s58, s58, 1
  s_waitcnt vmcnt(0)
  v_and_b32 v20, -8, v20
  v_cmp_ne_u64 vcc, s[42:43], v[20:21]
  s_cmp_eq_u32 s58, 0
  s_nop 3
  s_cbranch_scc1 Lpolld_f2_15
  s_cbranch_vccnz Lpoll_f2_14
Lpolld_f2_15:
  buffer_load_dwordx4 v[64:67], v6, s[32:35], s64 offen offset:0 sc1
  buffer_load_dwordx4 v[68:71], v6, s[32:35], s64 offen offset:1024 sc1
  buffer_load_dwordx4 v[72:75], v6, s[32:35], s64 offen offset:2048 sc1
  buffer_load_dwordx4 v[76:79], v6, s[32:35], s64 offen offset:3072 sc1
  s_add_u32 s64, s64, 4096
  buffer_load_dwordx4 v[80:83], v6, s[32:35], s64 offen offset:0 sc1
  buffer_load_dwordx4 v[84:87], v6, s[32:35], s64 offen offset:1024 sc1
  buffer_load_dwordx4 v[88:91], v6, s[32:35], s64 offen offset:2048 sc1
  buffer_load_dwordx4 v[92:95], v6, s[32:35], s64 offen offset:3072 sc1
  s_waitcnt vmcnt(7) lgkmcnt(8)
  ds_read_b64_tr_b16 v[152:153], v160 offset:4096
  ds_read_b64_tr_b16 v[154:155], v160 offset:6144
  ds_read_b64_tr_b16 v[156:157], v161 offset:4096
  ds_read_b64_tr_b16 v[158:159], v161 offset:6144
  v_mfma_f32_32x32x16_bf16 v[48:63], v[132:135], v[64:67], 0
  s_add_u32 s64, s64, 4096
  buffer_load_dwordx4 v[96:99], v6, s[32:35], s64 offen offset:0 sc1
  v_mfma_f32_32x32x16_bf16 v[32:47], v[128:131], v[64:67], 0
  s_waitcnt vmcnt(7) lgkmcnt(8)
  ds_read_b64_tr_b16 v[128:129], v160 offset:7168
  ds_read_b64_tr_b16 v[130:131], v160 offset:9216
  ds_read_b64_tr_b16 v[132:133], v161 offset:7168
  ds_read_b64_tr_b16 v[134:135], v161 offset:9216
  v_mfma_f32_32x32x16_bf16 v[48:63], v[140:143], v[68:71], v[48:63]
  buffer_load_dwordx4 v[100:103], v6, s[32:35], s64 offen offset:1024 sc1
  v_mfma_f32_32x32x16_bf16 v[32:47], v[136:139], v[68:71], v[32:47]
  s_waitcnt vmcnt(7) lgkmcnt(8)
  ds_read_b64_tr_b16 v[136:137], v160 offset:8192
  ds_read_b64_tr_b16 v[138:139], v160 offset:10240
  ds_read_b64_tr_b16 v[140:141], v161 offset:8192
  ds_read_b64_tr_b16 v[142:143], v161 offset:10240
  v_mfma_f32_32x32x16_bf16 v[48:63], v[148:151], v[72:75], v[48:63]
  buffer_load_dwordx4 v[104:107], v6, s[32:35], s64 offen offset:2048 sc1
  v_mfma_f32_32x32x16_bf16 v[32:47], v[144:147], v[72:75], v[32:47]
  s_waitcnt vmcnt(7) lgkmcnt(8)
  ds_read_b64_tr_b16 v[144:145], v160 offset:10240
  ds_read_b64_tr_b16 v[146:147], v160 offset:12288
  ds_read_b64_tr_b16 v[148:149], v161 offset:10240
  ds_read_b64_tr_b16 v[150:151], v161 offset:12288
  v_mfma_f32_32x32x16_bf16 v[48:63], v[156:159], v[76:79], v[48:63]
  buffer_load_dwordx4 v[108:111], v6, s[32:35], s64 offen offset:3072 sc1
  v_mfma_f32_32x32x16_bf16 v[32:47], v[152:155], v[76:79], v[32:47]
  s_waitcnt vmcnt(7) lgkmcnt(8)
  ds_read_b64_tr_b16 v[152:153], v160 offset:11264
  ds_read_b64_tr_b16 v[154:155], v160 offset:13312
  ds_read_b64_tr_b16 v[156:157], v161 offset:11264
  ds_read_b64_tr_b16 v[158:159], v161 offset:13312
  v_mfma_f32_32x32x16_bf16 v[48:63], v[132:135], v[80:83], v[48:63]
  s_add_u32 s64, s64, 4096
  buffer_load_dwordx4 v[112:115], v6, s[32:35], s64 offen offset:0 sc1
  v_mfma_f32_32x32x16_bf16 v[32:47], v[128:131], v[80:83], v[32:47]
  s_waitcnt vmcnt(7) lgkmcnt(8)
  ds_read_b64_tr_b16 v[128:129], v160 offset:14336
  ds_read_b64_tr_b16 v[130:131], v160 offset:16384
  ds_read_b64_tr_b16 v[132:133], v161 offset:14336
  ds_read_b64_tr_b16 v[134:135], v161 offset:16384
  v_mfma_f32_32x32x16_bf16 v[48:63], v[140:143], v[84:87], v[48:63]
  buffer_load_dwordx4 v[116:119], v6, s[32:35], s64 offen offset:1024 sc1
  v_mfma_f32_32x32x16_bf16 v[32:47], v[136:139], v[84:87], v[32:47]
  s_waitcnt vmcnt(7) lgkmcnt(8)
  ds_read_b64_tr_b16 v[136:137], v160 offset:15360
  ds_read_b64_tr_b16 v[138:139], v160 offset:17408
  ds_read_b64_tr_b16 v[140:141], v161 offset:15360
  ds_read_b64_tr_b16 v[142:143], v161 offset:17408
  v_mfma_f32_32x32x16_bf16 v[48:63], v[148:151], v[88:91], v[48:63]
  buffer_load_dwordx4 v[120:123], v6, s[32:35], s64 offen offset:2048 sc1
  v_mfma_f32_32x32x16_bf16 v[32:47], v[144:147], v[88:91], v[32:47]
  s_waitcnt vmcnt(7) lgkmcnt(8)
  ds_read_b64_tr_b16 v[144:145], v160 offset:17408
  ds_read_b64_tr_b16 v[146:147], v160 offset:19456
  ds_read_b64_tr_b16 v[148:149], v161 offset:17408
  ds_read_b64_tr_b16 v[150:151], v161 offset:19456
  v_mfma_f32_32x32x16_bf16 v[48:63], v[156:159], v[92:95], v[48:63]
  buffer_load_dwordx4 v[124:127], v6, s[32:35], s64 offen offset:3072 sc1
  v_mfma_f32_32x32x16_bf16 v[32:47], v[152:155], v[92:95], v[32:47]
  s_waitcnt vmcnt(7) lgkmcnt(8)
  ds_read_b64_tr_b16 v[152:153], v160 offset:18432
  ds_read_b64_tr_b16 v[154:155], v160 offset:20480
  ds_read_b64_tr_b16 v[156:157], v161 offset:18432
  ds_read_b64_tr_b16 v[158:159], v161 offset:20480
  v_mfma_f32_32x32x16_bf16 v[48:63], v[132:135], v[96:99], v[48:63]
  v_mfma_f32_32x32x16_bf16 v[32:47], v[128:131], v[96:99], v[32:47]
  s_waitcnt vmcnt(6) lgkmcnt(8)
  ds_read_b64_tr_b16 v[128:129], v160 offset:21504
  ds_read_b64_tr_b16 v[130:131], v160 offset:23552
  ds_read_b64_tr_b16 v[132:133], v161 offset:21504
  ds_read_b64_tr_b16 v[134:135], v161 offset:23552
  v_mfma_f32_32x32x16_bf16 v[48:63], v[140:143], v[100:103], v[48:63]
  v_mfma_f32_32x32x16_bf16 v[32:47], v[136:139], v[100:103], v[32:47]
  s_waitcnt vmcnt(5) lgkmcnt(8)
  ds_read_b64_tr_b16 v[136:137], v160 offset:22528
  ds_read_b64_tr_b16 v[138:139], v160 offset:24576
  ds_read_b64_tr_b16 v[140:141], v161 offset:22528
  ds_read_b64_tr_b16 v[142:143], v161 offset:24576
  v_mfma_f32_32x32x16_bf16 v[48:63], v[148:151], v[104:107], v[48:63]
  v_mfma_f32_32x32x16_bf16 v[32:47], v[144:147], v[104:107], v[32:47]
  s_waitcnt vmcnt(4) lgkmcnt(8)
  ds_read_b64_tr_b16 v[144:145], v160 offset:24576
  ds_read_b64_tr_b16 v[146:147], v160 offset:26624
  ds_read_b64_tr_b16 v[148:149], v161 offset:24576
  ds_read_b64_tr_b16 v[150:151], v161 offset:26624
  v_mfma_f32_32x32x16_bf16 v[48:63], v[156:159], v[108:111], v[48:63]
  v_mfma_f32_32x32x16_bf16 v[32:47], v[152:155], v[108:111], v[32:47]
  s_waitcnt vmcnt(3) lgkmcnt(8)
  ds_read_b64_tr_b16 v[152:153], v160 offset:25600
  ds_read_b64_tr_b16 v[154:155], v160 offset:27648
  ds_read_b64_tr_b16 v[156:157], v161 offset:25600
  ds_read_b64_tr_b16 v[158:159], v161 offset:27648
  v_mfma_f32_32x32x16_bf16 v[48:63], v[132:135], v[112:115], v[48:63]
  v_mfma_f32_32x32x16_bf16 v[32:47], v[128:131], v[112:115], v[32:47]
  s_waitcnt vmcnt(2) lgkmcnt(8)
  v_mfma_f32_32x32x16_bf16 v[48:63], v[140:143], v[116:119], v[48:63]
  v_mfma_f32_32x32x16_bf16 v[32:47], v[136:139], v[116:119], v[32:47]
  s_waitcnt vmcnt(1) lgkmcnt(4)
  v_mfma_f32_32x32x16_bf16 v[48:63], v[148:151], v[120:123], v[48:63]
  v_mfma_f32_32x32x16_bf16 v[32:47], v[144:147], v[120:123], v[32:47]
  s_waitcnt vmcnt(0) lgkmcnt(0)
  v_mfma_f32_32x32x16_bf16 v[48:63], v[156:159], v[124:127], v[48:63]
  v_mfma_f32_32x32x16_bf16 v[32:47], v[152:155], v[124:127], v[32:47]
  s_nop 7
  s_nop 2
  ds_write_b128 v162, v[48:51] offset:0
  ds_write_b128 v162, v[52:55] offset:1024
  ds_write_b128 v162, v[56:59] offset:2048
  ds_write_b128 v162, v[60:63] offset:3072
  s_waitcnt lgkmcnt(0)
  s_barrier
  ds_read_b128 v[48:51], v163 offset:0
  ds_read_b128 v[52:55], v163 offset:1024
  ds_read_b128 v[56:59], v163 offset:2048
  ds_read_b128 v[60:63], v163 offset:3072
  s_waitcnt lgkmcnt(3)
  v_pk_add_f32 v[32:33], v[32:33], v[48:49]
  v_pk_add_f32 v[34:35], v[34:35], v[50:51]
  v_cvt_pk_bf16_f32 v48, v32, v33
  v_cvt_pk_bf16_f32 v50, v34, v35
  v_lshlrev_b32 v32, 16, v48
  v_and_b32 v33, 0xffff0000, v48
  v_lshlrev_b32 v34, 16, v50
  v_and_b32 v35, 0xffff0000, v50
  v_pk_add_f32 v[32:33], v[32:33], v[168:169]
  v_pk_add_f32 v[34:35], v[34:35], v[170:171]
  v_cvt_pk_bf16_f32 v8, v32, v33
  v_cvt_pk_bf16_f32 v9, v34, v35
  s_waitcnt lgkmcnt(2)
  v_pk_add_f32 v[36:37], v[36:37], v[52:53]
  v_pk_add_f32 v[38:39], v[38:39], v[54:55]
  v_cvt_pk_bf16_f32 v52, v36, v37
  v_cvt_pk_bf16_f32 v54, v38, v39
  v_lshlrev_b32 v36, 16, v52
  v_and_b32 v37, 0xffff0000, v52
  v_lshlrev_b32 v38, 16, v54
  v_and_b32 v39, 0xffff0000, v54
  v_pk_add_f32 v[36:37], v[36:37], v[172:173]
  v_pk_add_f32 v[38:39], v[38:39], v[174:175]
  v_cvt_pk_bf16_f32 v10, v36, v37
  v_cvt_pk_bf16_f32 v11, v38, v39
  s_waitcnt lgkmcnt(1)
  v_pk_add_f32 v[40:41], v[40:41], v[56:57]
  v_pk_add_f32 v[42:43], v[42:43], v[58:59]
  v_cvt_pk_bf16_f32 v56, v40, v41
  v_cvt_pk_bf16_f32 v58, v42, v43
  v_lshlrev_b32 v40, 16, v56
  v_and_b32 v41, 0xffff0000, v56
  v_lshlrev_b32 v42, 16, v58
  v_and_b32 v43, 0xffff0000, v58
  v_pk_add_f32 v[40:41], v[40:41], v[176:177]
  v_pk_add_f32 v[42:43], v[42:43], v[178:179]
  v_cvt_pk_bf16_f32 v12, v40, v41
  v_cvt_pk_bf16_f32 v13, v42, v43
  s_waitcnt lgkmcnt(0)
  v_pk_add_f32 v[44:45], v[44:45], v[60:61]
  v_pk_add_f32 v[46:47], v[46:47], v[62:63]
  v_cvt_pk_bf16_f32 v60, v44, v45
  v_cvt_pk_bf16_f32 v62, v46, v47
  v_lshlrev_b32 v44, 16, v60
  v_and_b32 v45, 0xffff0000, v60
  v_lshlrev_b32 v46, 16, v62
  v_and_b32 v47, 0xffff0000, v62
  v_pk_add_f32 v[44:45], v[44:45], v[180:181]
  v_pk_add_f32 v[46:47], v[46:47], v[182:183]
  v_cvt_pk_bf16_f32 v14, v44, v45
  v_cvt_pk_bf16_f32 v15, v46, v47
  v_mov_b32 v48, 0
  v_mov_b32 v49, 0
  s_cmp_eq_u32 s41, 0
  s_nop 1
  s_cbranch_scc1 Lslow_16
  buffer_store_dwordx4 v[8:11], v164, s[32:35], s74 offen
  buffer_store_dwordx4 v[12:15], v164, s[32:35], s74 offen offset:512
  v_dot2c_f32_bf16 v48, v8, v167
  v_dot2c_f32_bf16 v49, v8, v8
  v_dot2c_f32_bf16 v48, v9, v167
  v_dot2c_f32_bf16 v49, v9, v9
  v_dot2c_f32_bf16 v48, v10, v167
  v_dot2c_f32_bf16 v49, v10, v10
  v_dot2c_f32_bf16 v48, v11, v167
  v_dot2c_f32_bf16 v49, v11, v11
  v_dot2c_f32_bf16 v48, v12, v167
  v_dot2c_f32_bf16 v49, v12, v12
  v_dot2c_f32_bf16 v48, v13, v167
  v_dot2c_f32_bf16 v49, v13, v13
  v_dot2c_f32_bf16 v48, v14, v167
  v_dot2c_f32_bf16 v49, v14, v14
  v_dot2c_f32_bf16 v48, v15, v167
  v_dot2c_f32_bf16 v49, v15, v15
  s_nop 1
  v_mov_b32 v50, v48
  v_mov_b32 v51, v49
  s_nop 0
  v_permlane32_swap_b32 v48, v50
  v_permlane32_swap_b32 v49, v51
  v_pk_add_f32 v[48:49], v[48:49], v[50:51]
  buffer_store_dwordx2 v[48:49], v165, s[32:35], s75 offen
  s_nop 1
  s_branch Lpub_17
Lslow_16:
  buffer_store_dwordx4 v[8:11], v164, s[32:35], s74 offen sc1
  buffer_store_dwordx4 v[12:15], v164, s[32:35], s74 offen offset:512 sc1
  v_dot2c_f32_bf16 v48, v8, v167
  v_dot2c_f32_bf16 v49, v8, v8
  v_dot2c_f32_bf16 v48, v9, v167
  v_dot2c_f32_bf16 v49, v9, v9
  v_dot2c_f32_bf16 v48, v10, v167
  v_dot2c_f32_bf16 v49, v10, v10
  v_dot2c_f32_bf16 v48, v11, v167
  v_dot2c_f32_bf16 v49, v11, v11
  v_dot2c_f32_bf16 v48, v12, v167
  v_dot2c_f32_bf16 v49, v12, v12
  v_dot2c_f32_bf16 v48, v13, v167
  v_dot2c_f32_bf16 v49, v13, v13
  v_dot2c_f32_bf16 v48, v14, v167
  v_dot2c_f32_bf16 v49, v14, v14
  v_dot2c_f32_bf16 v48, v15, v167
  v_dot2c_f32_bf16 v49, v15, v15
  s_nop 1
  v_mov_b32 v50, v48
  v_mov_b32 v51, v49
  s_nop 0
  v_permlane32_swap_b32 v48, v50
  v_permlane32_swap_b32 v49, v51
  v_pk_add_f32 v[48:49], v[48:49], v[50:51]
  buffer_store_dwordx2 v[48:49], v165, s[32:35], s75 offen sc1
  s_nop 1
Lpub_17:
  v_lshrrev_b32 v18, 1, v5
  v_lshlrev_b32 v18, 4, v18
  v_and_b32 v19, 1, v5
  v_lshl_add_u32 v18, v19, 2, v18
  v_lshrrev_b32 v19, 2, v4
  v_add_u32 v18, v18, v19
  v_mul_u32_u24 v18, 224, v18
  v_and_b32 v19, 3, v1
  v_lshl_add_u32 v254, v19, 3, v18
  v_add_u32 v255, 57344, v254
  v_add_u32 v27, 144384, v254
  s_lshl_b32 s61, s73, 7
  s_add_u32 s61, s61, 17956864
  v_min_u32 v18, 13, v4
  v_lshlrev_b32 v18, 3, v18
  v_add_u32 v18, s61, v18
  s_mul_i32 s64, s73, 86016
  s_add_u32 s78, s64, 14336
  s_lshl_b32 s63, s73, 12
  s_add_u32 s63, s63, 18087936
  v_mul_u32_u24 v28, 1792, v3
  v_lshl_add_u32 v28, v2, 3, v28
  s_mul_i32 s74, s73, 114688
  s_mul_i32 s65, s37, 7168
  s_add_u32 s74, s74, s65
  s_add_u32 s74, s74, 10485760
  s_add_u32 s75, s74, 4096
  s_lshl_b32 s79, s73, 7
  s_lshl_b32 s65, s37, 3
  s_add_u32 s79, s79, s65
  s_add_u32 s79, s79, 18022400
  s_cmp_eq_u32 s41, 0
  s_cbranch_scc1 Lslow_18
  s_waitcnt vmcnt(0)
  s_mov_b64 exec, 1
  buffer_store_dwordx2 v[16:17], v24, s[32:35], s76 offen
  s_mov_b64 exec, -1
  s_branch Lpub_19
Lslow_18:
  s_waitcnt vmcnt(0)
  s_mov_b64 exec, 1
  buffer_store_dwordx2 v[16:17], v24, s[32:35], s76 offen sc1
  s_mov_b64 exec, -1
Lpub_19:
  s_branch Lp3_done
Lp3_idle:
  v_lshrrev_b32 v18, 1, v5
  v_lshlrev_b32 v18, 4, v18
  v_and_b32 v19, 1, v5
  v_lshl_add_u32 v18, v19, 2, v18
  v_lshrrev_b32 v19, 2, v4
  v_add_u32 v18, v18, v19
  v_mul_u32_u24 v18, 224, v18
  v_and_b32 v19, 3, v1
  v_lshl_add_u32 v254, v19, 3, v18
  v_add_u32 v255, 57344, v254
  v_add_u32 v27, 144384, v254
  s_lshl_b32 s61, s73, 7
  s_add_u32 s61, s61, 17956864
  v_min_u32 v18, 13, v4
  v_lshlrev_b32 v18, 3, v18
  v_add_u32 v18, s61, v18
  s_mul_i32 s64, s73, 86016
  s_add_u32 s78, s64, 14336
  s_lshl_b32 s63, s73, 12
  s_add_u32 s63, s63, 18087936
  v_mul_u32_u24 v28, 1792, v3
  v_lshl_add_u32 v28, v2, 3, v28
  s_mul_i32 s74, s73, 114688
  s_mul_i32 s65, s37, 7168
  s_add_u32 s74, s74, s65
  s_add_u32 s74, s74, 10485760
  s_add_u32 s75, s74, 4096
  s_lshl_b32 s79, s73, 7
  s_lshl_b32 s65, s37, 3
  s_add_u32 s79, s79, s65
  s_add_u32 s79, s79, 18022400
  s_barrier
  s_barrier
Lp3_done:
  s_barrier
  ds_read_b64_tr_b16 v[200:201], v254 offset:0
  ds_read_b64_tr_b16 v[202:203], v254 offset:1792
  ds_read_b64_tr_b16 v[204:205], v254 offset:32
  ds_read_b64_tr_b16 v[206:207], v254 offset:1824
  ds_read_b64_tr_b16 v[208:209], v254 offset:64
  ds_read_b64_tr_b16 v[210:211], v254 offset:1856
  ds_read_b64_tr_b16 v[212:213], v254 offset:96
  ds_read_b64_tr_b16 v[214:215], v254 offset:1888
  ds_read_b64_tr_b16 v[216:217], v254 offset:7168
  ds_read_b64_tr_b16 v[218:219], v254 offset:8960
  ds_read_b64_tr_b16 v[220:221], v254 offset:7200
  ds_read_b64_tr_b16 v[222:223], v254 offset:8992
  s_mov_b32 s58, 0x20000
Lpoll_f3_20:
  buffer_load_dwordx2 v[20:21], v18, s[32:35], 0 offen sc1
  s_sub_u32 s58, s58, 1
  s_waitcnt vmcnt(0)
  v_and_b32 v20, -8, v20
  v_cmp_ne_u64 vcc, s[42:43], v[20:21]
  s_cmp_eq_u32 s58, 0
  s_nop 3
  s_cbranch_scc1 Lpolld_f3_21
  s_cbranch_vccnz Lpoll_f3_20
Lpolld_f3_21:
  buffer_load_dwordx4 v[32:35], v6, s[32:35], s64 offen offset:0 sc1
  buffer_load_dwordx4 v[88:91], v6, s[32:35], s78 offen offset:0 sc1
  buffer_load_dwordx4 v[36:39], v6, s[32:35], s64 offen offset:1024 sc1
  buffer_load_dwordx4 v[92:95], v6, s[32:35], s78 offen offset:1024 sc1
  buffer_load_dwordx2 v[232:233], v28, s[32:35], s63 offen offset:0 sc1
  buffer_load_dwordx2 v[234:235], v28, s[32:35], s63 offen offset:256 sc1
  buffer_load_dwordx2 v[236:237], v28, s[32:35], s63 offen offset:512 sc1
  buffer_load_dwordx2 v[238:239], v28, s[32:35], s63 offen offset:768 sc1
  buffer_load_dwordx2 v[240:241], v28, s[32:35], s63 offen offset:1024 sc1
  buffer_load_dwordx2 v[242:243], v28, s[32:35], s63 offen offset:1280 sc1
  buffer_load_dwordx2 v[244:245], v28, s[32:35], s63 offen offset:1536 sc1
  buffer_load_dwordx4 v[40:43], v6, s[32:35], s64 offen offset:2048 sc1
  buffer_load_dwordx4 v[96:99], v6, s[32:35], s78 offen offset:2048 sc1
  buffer_load_dwordx4 v[44:47], v6, s[32:35], s64 offen offset:3072 sc1
  buffer_load_dwordx4 v[100:103], v6, s[32:35], s78 offen offset:3072 sc1
  s_add_u32 s64, s64, 4096
  s_add_u32 s78, s78, 4096
  buffer_load_dwordx4 v[48:51], v6, s[32:35], s64 offen offset:0 sc1
  buffer_load_dwordx4 v[104:107], v6, s[32:35], s78 offen offset:0 sc1
  buffer_load_dwordx4 v[52:55], v6, s[32:35], s64 offen offset:1024 sc1
  buffer_load_dwordx4 v[108:111], v6, s[32:35], s78 offen offset:1024 sc1
  buffer_load_dwordx4 v[56:59], v6, s[32:35], s64 offen offset:2048 sc1
  buffer_load_dwordx4 v[112:115], v6, s[32:35], s78 offen offset:2048 sc1
  buffer_load_dwordx4 v[60:63], v6, s[32:35], s64 offen offset:3072 sc1
  buffer_load_dwordx4 v[116:119], v6, s[32:35], s78 offen offset:3072 sc1
  v_lshlrev_b32 v7, 4, v5
  v_add_u32 v7, 162240, v7
  v_lshlrev_b32 v18, 9, v5
  v_lshl_add_u32 v18, v4, 4, v18
  v_lshrrev_b32 v19, 1, v5
  v_lshlrev_b32 v19, 9, v19
  v_lshl_add_u32 v19, v4, 4, v19
  v_and_b32 v21, 1, v5
  v_lshl_add_u32 v19, v21, 3, v19
  s_waitcnt vmcnt(21) lgkmcnt(8)
  ds_read_b64_tr_b16 v[224:225], v254 offset:7232
  ds_read_b64_tr_b16 v[226:227], v254 offset:9024
  v_mfma_f32_16x16x32_bf16 v[144:147], v[200:203], v[32:35], 0
  v_mfma_f32_16x16x32_bf16 v[172:175], v[200:203], v[88:91], 0
  s_add_u32 s64, s64, 4096
  s_add_u32 s78, s78, 4096
  buffer_load_dwordx4 v[64:67], v6, s[32:35], s64 offen offset:0 sc1
  ds_read_b64_tr_b16 v[228:229], v254 offset:7264
  ds_read_b64_tr_b16 v[230:231], v254 offset:9056
  v_mfma_f32_16x16x32_bf16 v[148:151], v[204:207], v[32:35], 0
  v_mfma_f32_16x16x32_bf16 v[176:179], v[204:207], v[88:91], 0
  buffer_load_dwordx4 v[120:123], v6, s[32:35], s78 offen offset:0 sc1
  s_waitcnt lgkmcnt(8)
  ds_read_b64_tr_b16 v[200:201], v254 offset:14336
  ds_read_b64_tr_b16 v[202:203], v254 offset:16128
  v_mfma_f32_16x16x32_bf16 v[152:155], v[208:211], v[32:35], 0
  v_mfma_f32_16x16x32_bf16 v[180:183], v[208:211], v[88:91], 0
  ds_read_b64_tr_b16 v[204:205], v254 offset:14368
  ds_read_b64_tr_b16 v[206:207], v254 offset:16160
  v_mfma_f32_16x16x32_bf16 v[156:159], v[212:215], v[32:35], 0
  v_mfma_f32_16x16x32_bf16 v[184:187], v[212:215], v[88:91], 0
  s_waitcnt vmcnt(21) lgkmcnt(8)
  ds_read_b64_tr_b16 v[208:209], v254 offset:14400
  ds_read_b64_tr_b16 v[210:211], v254 offset:16192
  v_mfma_f32_16x16x32_bf16 v[144:147], v[216:219], v[36:39], v[144:147]
  v_mfma_f32_16x16x32_bf16 v[172:175], v[216:219], v[92:95], v[172:175]
  buffer_load_dwordx4 v[68:71], v6, s[32:35], s64 offen offset:1024 sc1
  ds_read_b64_tr_b16 v[212:213], v254 offset:14432
  ds_read_b64_tr_b16 v[214:215], v254 offset:16224
  v_mfma_f32_16x16x32_bf16 v[148:151], v[220:223], v[36:39], v[148:151]
  v_mfma_f32_16x16x32_bf16 v[176:179], v[220:223], v[92:95], v[176:179]
  buffer_load_dwordx4 v[124:127], v6, s[32:35], s78 offen offset:1024 sc1
  s_waitcnt lgkmcnt(8)
  ds_read_b64_tr_b16 v[216:217], v254 offset:21504
  ds_read_b64_tr_b16 v[218:219], v254 offset:23296
  v_mfma_f32_16x16x32_bf16 v[152:155], v[224:227], v[36:39], v[152:155]
  v_mfma_f32_16x16x32_bf16 v[180:183], v[224:227], v[92:95], v[180:183]
  ds_read_b64_tr_b16 v[220:221], v254 offset:21536
  ds_read_b64_tr_b16 v[222:223], v254 offset:23328
  v_mfma_f32_16x16x32_bf16 v[156:159], v[228:231], v[36:39], v[156:159]
  v_mfma_f32_16x16x32_bf16 v[184:187], v[228:231], v[92:95], v[184:187]
  s_waitcnt vmcnt(14) lgkmcnt(8)
  ds_read_b64_tr_b16 v[224:225], v254 offset:21568
  ds_read_b64_tr_b16 v[226:227], v254 offset:23360
  v_mfma_f32_16x16x32_bf16 v[144:147], v[200:203], v[40:43], v[144:147]
  v_mfma_f32_16x16x32_bf16 v[172:175], v[200:203], v[96:99], v[172:175]
  buffer_load_dwordx4 v[72:75], v6, s[32:35], s64 offen offset:2048 sc1
  ds_read_b64_tr_b16 v[228:229], v254 offset:21600
  ds_read_b64_tr_b16 v[230:231], v254 offset:23392
  v_mfma_f32_16x16x32_bf16 v[148:151], v[204:207], v[40:43], v[148:151]
  v_mfma_f32_16x16x32_bf16 v[176:179], v[204:207], v[96:99], v[176:179]
  buffer_load_dwordx4 v[128:131], v6, s[32:35], s78 offen offset:2048 sc1
  s_waitcnt lgkmcnt(8)
  ds_read_b64_tr_b16 v[200:201], v254 offset:28672
  ds_read_b64_tr_b16 v[202:203], v254 offset:30464
  v_mfma_f32_16x16x32_bf16 v[152:155], v[208:211], v[40:43], v[152:155]
  v_mfma_f32_16x16x32_bf16 v[180:183], v[208:211], v[96:99], v[180:183]
  ds_read_b64_tr_b16 v[204:205], v254 offset:28704
  ds_read_b64_tr_b16 v[206:207], v254 offset:30496
  v_mfma_f32_16x16x32_bf16 v[156:159], v[212:215], v[40:43], v[156:159]
  v_mfma_f32_16x16x32_bf16 v[184:187], v[212:215], v[96:99], v[184:187]
  v_pk_add_f32 v[232:233], v[232:233], v[234:235]
  v_pk_add_f32 v[232:233], v[232:233], v[236:237]
  v_pk_add_f32 v[232:233], v[232:233], v[238:239]
  v_pk_add_f32 v[232:233], v[232:233], v[240:241]
  v_pk_add_f32 v[232:233], v[232:233], v[242:243]
  v_pk_add_f32 v[232:233], v[232:233], v[244:245]
  v_mov_b32 v234, v232
  s_nop 1
  v_permlane32_swap_b32 v232, v234
  v_add_f32 v232, v232, v234
  v_mov_b32 v234, v233
  s_nop 1
  v_permlane32_swap_b32 v233, v234
  v_add_f32 v233, v233, v234
  v_mul_f32 v232, 0x3b124925, v232
  v_mul_f32 v233, 0x3b124925, v233
  v_fma_f32 v233, -v232, v232, v233
  v_max_f32 v233, 0, v233
  v_cvt_pk_bf16_f32 v233, v233, v233
  v_and_b32 v233, 0xffff0000, v233
  v_add_f32 v233, 0x3727c5ac, v233
  v_cvt_pk_bf16_f32 v233, v233, v233
  v_and_b32 v233, 0xffff0000, v233
  v_sqrt_f32 v233, v233
  s_nop 0
  v_cvt_pk_bf16_f32 v233, v233, v233
  v_and_b32 v233, 0xffff0000, v233
  v_rcp_f32 v250, v233
  v_cvt_pk_bf16_f32 v234, v232, v232
  v_and_b32 v234, 0xffff0000, v234
  v_sub_f32 v246, 0, v234
  v_mul_f32 v246, v246, v250
  v_mov_b32 v248, v246
  v_mov_b32 v252, v250
  s_nop 0
  v_permlane16_swap_b32 v246, v248
  v_permlane16_swap_b32 v250, v252
  v_mov_b32 v247, v246
  v_mov_b32 v249, v248
  v_mov_b32 v251, v250
  v_mov_b32 v253, v252
  s_waitcnt vmcnt(14) lgkmcnt(8)
  ds_read_b64_tr_b16 v[208:209], v254 offset:28736
  ds_read_b64_tr_b16 v[210:211], v254 offset:30528
  v_mfma_f32_16x16x32_bf16 v[144:147], v[216:219], v[44:47], v[144:147]
  v_mfma_f32_16x16x32_bf16 v[172:175], v[216:219], v[100:103], v[172:175]
  buffer_load_dwordx4 v[76:79], v6, s[32:35], s64 offen offset:3072 sc1
  s_barrier
  ds_read_b64_tr_b16 v[212:213], v254 offset:28768
  ds_read_b64_tr_b16 v[214:215], v254 offset:30560
  v_mfma_f32_16x16x32_bf16 v[148:151], v[220:223], v[44:47], v[148:151]
  v_mfma_f32_16x16x32_bf16 v[176:179], v[220:223], v[100:103], v[176:179]
  buffer_load_dwordx4 v[132:135], v6, s[32:35], s78 offen offset:3072 sc1
  s_waitcnt lgkmcnt(8)
  ds_read_b64_tr_b16 v[216:217], v254 offset:35840
  ds_read_b64_tr_b16 v[218:219], v254 offset:37632
  v_mfma_f32_16x16x32_bf16 v[152:155], v[224:227], v[44:47], v[152:155]
  v_mfma_f32_16x16x32_bf16 v[180:183], v[224:227], v[100:103], v[180:183]
  ds_read_b64_tr_b16 v[220:221], v254 offset:35872
  ds_read_b64_tr_b16 v[222:223], v254 offset:37664
  v_mfma_f32_16x16x32_bf16 v[156:159], v[228:231], v[44:47], v[156:159]
  v_mfma_f32_16x16x32_bf16 v[184:187], v[228:231], v[100:103], v[184:187]
  s_waitcnt vmcnt(14) lgkmcnt(8)
  ds_read_b64_tr_b16 v[224:225], v254 offset:35904
  ds_read_b64_tr_b16 v[226:227], v254 offset:37696
  v_mfma_f32_16x16x32_bf16 v[144:147], v[200:203], v[48:51], v[144:147]
  v_mfma_f32_16x16x32_bf16 v[172:175], v[200:203], v[104:107], v[172:175]
  s_add_u32 s64, s64, 4096
  s_add_u32 s78, s78, 4096
  buffer_load_dwordx4 v[80:83], v6, s[32:35], s64 offen offset:0 sc1
  ds_read_b64_tr_b16 v[228:229], v254 offset:35936
  ds_read_b64_tr_b16 v[230:231], v254 offset:37728
  v_mfma_f32_16x16x32_bf16 v[148:151], v[204:207], v[48:51], v[148:151]
  v_mfma_f32_16x16x32_bf16 v[176:179], v[204:207], v[104:107], v[176:179]
  buffer_load_dwordx4 v[136:139], v6, s[32:35], s78 offen offset:0 sc1
  s_waitcnt lgkmcnt(8)
  ds_read_b64_tr_b16 v[200:201], v254 offset:43008
  ds_read_b64_tr_b16 v[202:203], v254 offset:44800
  v_mfma_f32_16x16x32_bf16 v[152:155], v[208:211], v[48:51], v[152:155]
  v_mfma_f32_16x16x32_bf16 v[180:183], v[208:211], v[104:107], v[180:183]
  ds_read_b64_tr_b16 v[204:205], v254 offset:43040
  ds_read_b64_tr_b16 v[206:207], v254 offset:44832
  v_mfma_f32_16x16x32_bf16 v[156:159], v[212:215], v[48:51], v[156:159]
  v_mfma_f32_16x16x32_bf16 v[184:187], v[212:215], v[104:107], v[184:187]
  s_waitcnt vmcnt(14) lgkmcnt(8)
  ds_read_b64_tr_b16 v[208:209], v254 offset:43072
  ds_read_b64_tr_b16 v[210:211], v254 offset:44864
  v_mfma_f32_16x16x32_bf16 v[144:147], v[216:219], v[52:55], v[144:147]
  v_mfma_f32_16x16x32_bf16 v[172:175], v[216:219], v[108:111], v[172:175]
  buffer_load_dwordx4 v[84:87], v6, s[32:35], s64 offen offset:1024 sc1
  s_barrier
  ds_read_b64_tr_b16 v[212:213], v254 offset:43104
  ds_read_b64_tr_b16 v[214:215], v254 offset:44896
  v_mfma_f32_16x16x32_bf16 v[148:151], v[220:223], v[52:55], v[148:151]
  v_mfma_f32_16x16x32_bf16 v[176:179], v[220:223], v[108:111], v[176:179]
  buffer_load_dwordx4 v[140:143], v6, s[32:35], s78 offen offset:1024 sc1
  s_waitcnt lgkmcnt(8)
  ds_read_b64_tr_b16 v[216:217], v254 offset:50176
  ds_read_b64_tr_b16 v[218:219], v254 offset:51968
  v_mfma_f32_16x16x32_bf16 v[152:155], v[224:227], v[52:55], v[152:155]
  v_mfma_f32_16x16x32_bf16 v[180:183], v[224:227], v[108:111], v[180:183]
  ds_read_b64_tr_b16 v[220:221], v254 offset:50208
  ds_read_b64_tr_b16 v[222:223], v254 offset:52000
  v_mfma_f32_16x16x32_bf16 v[156:159], v[228:231], v[52:55], v[156:159]
  v_mfma_f32_16x16x32_bf16 v[184:187], v[228:231], v[108:111], v[184:187]
  s_waitcnt vmcnt(14) lgkmcnt(8)
  ds_read_b64_tr_b16 v[224:225], v254 offset:50240
  ds_read_b64_tr_b16 v[226:227], v254 offset:52032
  v_mfma_f32_16x16x32_bf16 v[144:147], v[200:203], v[56:59], v[144:147]
  v_mfma_f32_16x16x32_bf16 v[172:175], v[200:203], v[112:115], v[172:175]
  ds_read_b64_tr_b16 v[228:229], v254 offset:50272
  ds_read_b64_tr_b16 v[230:231], v254 offset:52064
  v_mfma_f32_16x16x32_bf16 v[148:151], v[204:207], v[56:59], v[148:151]
  v_mfma_f32_16x16x32_bf16 v[176:179], v[204:207], v[112:115], v[176:179]
  s_waitcnt lgkmcnt(8)
  ds_read_b64_tr_b16 v[200:201], v255 offset:0
  ds_read_b64_tr_b16 v[202:203], v255 offset:1792
  v_mfma_f32_16x16x32_bf16 v[152:155], v[208:211], v[56:59], v[152:155]
  v_mfma_f32_16x16x32_bf16 v[180:183], v[208:211], v[112:115], v[180:183]
  ds_read_b64_tr_b16 v[204:205], v255 offset:32
  ds_read_b64_tr_b16 v[206:207], v255 offset:1824
  v_mfma_f32_16x16x32_bf16 v[156:159], v[212:215], v[56:59], v[156:159]
  v_mfma_f32_16x16x32_bf16 v[184:187], v[212:215], v[112:115], v[184:187]
  s_waitcnt vmcnt(12) lgkmcnt(8)
  ds_read_b64_tr_b16 v[208:209], v255 offset:64
  ds_read_b64_tr_b16 v[210:211], v255 offset:1856
  v_mfma_f32_16x16x32_bf16 v[144:147], v[216:219], v[60:63], v[144:147]
  v_mfma_f32_16x16x32_bf16 v[172:175], v[216:219], v[116:119], v[172:175]
  ds_read_b64_tr_b16 v[212:213], v255 offset:96
  ds_read_b64_tr_b16 v[214:215], v255 offset:1888
  v_mfma_f32_16x16x32_bf16 v[148:151], v[220:223], v[60:63], v[148:151]
  v_mfma_f32_16x16x32_bf16 v[176:179], v[220:223], v[116:119], v[176:179]
  s_waitcnt lgkmcnt(8)
  ds_read_b64_tr_b16 v[216:217], v255 offset:7168
  ds_read_b64_tr_b16 v[218:219], v255 offset:8960
  v_mfma_f32_16x16x32_bf16 v[152:155], v[224:227], v[60:63], v[152:155]
  v_mfma_f32_16x16x32_bf16 v[180:183], v[224:227], v[116:119], v[180:183]
  ds_read_b64_tr_b16 v[220:221], v255 offset:7200
  ds_read_b64_tr_b16 v[222:223], v255 offset:8992
  v_mfma_f32_16x16x32_bf16 v[156:159], v[228:231], v[60:63], v[156:159]
  v_mfma_f32_16x16x32_bf16 v[184:187], v[228:231], v[116:119], v[184:187]
  s_waitcnt vmcnt(10) lgkmcnt(8)
  ds_read_b64_tr_b16 v[224:225], v255 offset:7232
  ds_read_b64_tr_b16 v[226:227], v255 offset:9024
  v_mfma_f32_16x16x32_bf16 v[144:147], v[200:203], v[64:67], v[144:147]
  v_mfma_f32_16x16x32_bf16 v[172:175], v[200:203], v[120:123], v[172:175]
  ds_read_b64_tr_b16 v[228:229], v255 offset:7264
  ds_read_b64_tr_b16 v[230:231], v255 offset:9056
  v_mfma_f32_16x16x32_bf16 v[148:151], v[204:207], v[64:67], v[148:151]
  v_mfma_f32_16x16x32_bf16 v[176:179], v[204:207], v[120:123], v[176:179]
  s_waitcnt lgkmcnt(8)
  ds_read_b64_tr_b16 v[200:201], v255 offset:14336
  ds_read_b64_tr_b16 v[202:203], v255 offset:16128
  v_mfma_f32_16x16x32_bf16 v[152:155], v[208:211], v[64:67], v[152:155]
  v_mfma_f32_16x16x32_bf16 v[180:183], v[208:211], v[120:123], v[180:183]
  ds_read_b64_tr_b16 v[204:205], v255 offset:14368
  ds_read_b64_tr_b16 v[206:207], v255 offset:16160
  v_mfma_f32_16x16x32_bf16 v[156:159], v[212:215], v[64:67], v[156:159]
  v_mfma_f32_16x16x32_bf16 v[184:187], v[212:215], v[120:123], v[184:187]
  s_waitcnt vmcnt(8) lgkmcnt(8)
  ds_read_b64_tr_b16 v[208:209], v255 offset:14400
  ds_read_b64_tr_b16 v[210:211], v255 offset:16192
  v_mfma_f32_16x16x32_bf16 v[144:147], v[216:219], v[68:71], v[144:147]
  v_mfma_f32_16x16x32_bf16 v[172:175], v[216:219], v[124:127], v[172:175]
  ds_read_b64_tr_b16 v[212:213], v255 offset:14432
  ds_read_b64_tr_b16 v[214:215], v255 offset:16224
  v_mfma_f32_16x16x32_bf16 v[148:151], v[220:223], v[68:71], v[148:151]
  v_mfma_f32_16x16x32_bf16 v[176:179], v[220:223], v[124:127], v[176:179]
  s_waitcnt lgkmcnt(8)
  ds_read_b64_tr_b16 v[216:217], v255 offset:21504
  ds_read_b64_tr_b16 v[218:219], v255 offset:23296
  v_mfma_f32_16x16x32_bf16 v[152:155], v[224:227], v[68:71], v[152:155]
  v_mfma_f32_16x16x32_bf16 v[180:183], v[224:227], v[124:127], v[180:183]
  ds_read_b64_tr_b16 v[220:221], v255 offset:21536
  ds_read_b64_tr_b16 v[222:223], v255 offset:23328
  v_mfma_f32_16x16x32_bf16 v[156:159], v[228:231], v[68:71], v[156:159]
  v_mfma_f32_16x16x32_bf16 v[184:187], v[228:231], v[124:127], v[184:187]
  s_waitcnt vmcnt(6) lgkmcnt(8)
  ds_read_b64_tr_b16 v[224:225], v255 offset:21568
  ds_read_b64_tr_b16 v[226:227], v255 offset:23360
  v_mfma_f32_16x16x32_bf16 v[144:147], v[200:203], v[72:75], v[144:147]
  v_mfma_f32_16x16x32_bf16 v[172:175], v[200:203], v[128:131], v[172:175]
  ds_read_b64_tr_b16 v[228:229], v255 offset:21600
  ds_read_b64_tr_b16 v[230:231], v255 offset:23392
  v_mfma_f32_16x16x32_bf16 v[148:151], v[204:207], v[72:75], v[148:151]
  v_mfma_f32_16x16x32_bf16 v[176:179], v[204:207], v[128:131], v[176:179]
  s_waitcnt lgkmcnt(8)
  ds_read_b64_tr_b16 v[200:201], v27 offset:0
  ds_read_b64_tr_b16 v[202:203], v27 offset:1792
  v_mfma_f32_16x16x32_bf16 v[152:155], v[208:211], v[72:75], v[152:155]
  v_mfma_f32_16x16x32_bf16 v[180:183], v[208:211], v[128:131], v[180:183]
  ds_read_b64_tr_b16 v[204:205], v27 offset:32
  ds_read_b64_tr_b16 v[206:207], v27 offset:1824
  v_mfma_f32_16x16x32_bf16 v[156:159], v[212:215], v[72:75], v[156:159]
  v_mfma_f32_16x16x32_bf16 v[184:187], v[212:215], v[128:131], v[184:187]
  s_waitcnt vmcnt(4) lgkmcnt(8)
  ds_read_b64_tr_b16 v[208:209], v27 offset:64
  ds_read_b64_tr_b16 v[210:211], v27 offset:1856
  v_mfma_f32_16x16x32_bf16 v[144:147], v[216:219], v[76:79], v[144:147]
  v_mfma_f32_16x16x32_bf16 v[172:175], v[216:219], v[132:135], v[172:175]
  ds_read_b64_tr_b16 v[212:213], v27 offset:96
  ds_read_b64_tr_b16 v[214:215], v27 offset:1888
  v_mfma_f32_16x16x32_bf16 v[148:151], v[220:223], v[76:79], v[148:151]
  v_mfma_f32_16x16x32_bf16 v[176:179], v[220:223], v[132:135], v[176:179]
  s_waitcnt lgkmcnt(8)
  ds_read_b64_tr_b16 v[216:217], v27 offset:7168
  ds_read_b64_tr_b16 v[218:219], v27 offset:8960
  v_mfma_f32_16x16x32_bf16 v[152:155], v[224:227], v[76:79], v[152:155]
  v_mfma_f32_16x16x32_bf16 v[180:183], v[224:227], v[132:135], v[180:183]
  ds_read_b64_tr_b16 v[220:221], v27 offset:7200
  ds_read_b64_tr_b16 v[222:223], v27 offset:8992
  v_mfma_f32_16x16x32_bf16 v[156:159], v[228:231], v[76:79], v[156:159]
  v_mfma_f32_16x16x32_bf16 v[184:187], v[228:231], v[132:135], v[184:187]
  s_waitcnt vmcnt(2) lgkmcnt(8)
  ds_read_b64_tr_b16 v[224:225], v27 offset:7232
  ds_read_b64_tr_b16 v[226:227], v27 offset:9024
  v_mfma_f32_16x16x32_bf16 v[144:147], v[200:203], v[80:83], v[144:147]
  v_mfma_f32_16x16x32_bf16 v[172:175], v[200:203], v[136:139], v[172:175]
  ds_read_b64_tr_b16 v[228:229], v27 offset:7264
  ds_read_b64_tr_b16 v[230:231], v27 offset:9056
  v_mfma_f32_16x16x32_bf16 v[148:151], v[204:207], v[80:83], v[148:151]
  v_mfma_f32_16x16x32_bf16 v[176:179], v[204:207], v[136:139], v[176:179]
  s_waitcnt lgkmcnt(8)
  ds_read_b64_tr_b16 v[200:201], v254 offset:128
  ds_read_b64_tr_b16 v[202:203], v254 offset:1920
  v_mfma_f32_16x16x32_bf16 v[152:155], v[208:211], v[80:83], v[152:155]
  v_mfma_f32_16x16x32_bf16 v[180:183], v[208:211], v[136:139], v[180:183]
  ds_read_b64_tr_b16 v[204:205], v254 offset:160
  ds_read_b64_tr_b16 v[206:207], v254 offset:1952
  v_mfma_f32_16x16x32_bf16 v[156:159], v[212:215], v[80:83], v[156:159]
  v_mfma_f32_16x16x32_bf16 v[184:187], v[212:215], v[136:139], v[184:187]
  s_waitcnt vmcnt(0) lgkmcnt(8)
  ds_read_b64_tr_b16 v[208:209], v254 offset:192
  ds_read_b64_tr_b16 v[210:211], v254 offset:1984
  ds_read_b128 v[232:235], v7 offset:0
  ds_read_b128 v[236:239], v7 offset:64
  v_mfma_f32_16x16x32_bf16 v[144:147], v[216:219], v[84:87], v[144:147]
  v_mfma_f32_16x16x32_bf16 v[172:175], v[216:219], v[140:143], v[172:175]
  ds_read_b64_tr_b16 v[212:213], v254 offset:7296
  ds_read_b64_tr_b16 v[214:215], v254 offset:9088
  v_mfma_f32_16x16x32_bf16 v[148:151], v[220:223], v[84:87], v[148:151]
  v_mfma_f32_16x16x32_bf16 v[176:179], v[220:223], v[140:143], v[176:179]
  s_waitcnt lgkmcnt(10)
  ds_read_b64_tr_b16 v[216:217], v254 offset:7328
  ds_read_b64_tr_b16 v[218:219], v254 offset:9120
  ds_read_b128 v[240:243], v7 offset:128
  ds_read_b128 v[20:23], v7 offset:192
  v_mfma_f32_16x16x32_bf16 v[152:155], v[224:227], v[84:87], v[152:155]
  v_mfma_f32_16x16x32_bf16 v[180:183], v[224:227], v[140:143], v[180:183]
  ds_read_b64_tr_b16 v[220:221], v254 offset:7360
  ds_read_b64_tr_b16 v[222:223], v254 offset:9152
  v_mfma_f32_16x16x32_bf16 v[156:159], v[228:231], v[84:87], v[156:159]
  v_mfma_f32_16x16x32_bf16 v[184:187], v[228:231], v[140:143], v[184:187]
  s_waitcnt lgkmcnt(2)
  v_pk_mul_f32 v[144:145], v[144:145], v[250:251]
  v_pk_mul_f32 v[146:147], v[146:147], v[250:251]
  v_pk_mul_f32 v[148:149], v[148:149], v[250:251]
  v_pk_mul_f32 v[150:151], v[150:151], v[250:251]
  v_pk_fma_f32 v[144:145], v[232:233], v[246:247], v[144:145]
  v_pk_fma_f32 v[146:147], v[234:235], v[246:247], v[146:147]
  v_pk_fma_f32 v[148:149], v[236:237], v[246:247], v[148:149]
  v_pk_fma_f32 v[150:151], v[238:239], v[246:247], v[150:151]
  v_cvt_pk_bf16_f32 v144, v144, v145
  v_cvt_pk_bf16_f32 v145, v146, v147
  v_cvt_pk_bf16_f32 v146, v148, v149
  v_cvt_pk_bf16_f32 v147, v150, v151
  v_pk_max_i16 v144, v144, v24
  v_pk_max_i16 v145, v145, v24
  v_pk_max_i16 v146, v146, v24
  v_pk_max_i16 v147, v147, v24
  buffer_store_dwordx4 v[144:147], v18, s[32:35], s74 offen offset:0 sc1
  v_pk_mul_f32 v[172:173], v[172:173], v[252:253]
  v_pk_mul_f32 v[174:175], v[174:175], v[252:253]
  v_pk_mul_f32 v[176:177], v[176:177], v[252:253]
  v_pk_mul_f32 v[178:179], v[178:179], v[252:253]
  v_pk_fma_f32 v[172:173], v[232:233], v[248:249], v[172:173]
  v_pk_fma_f32 v[174:175], v[234:235], v[248:249], v[174:175]
  v_pk_fma_f32 v[176:177], v[236:237], v[248:249], v[176:177]
  v_pk_fma_f32 v[178:179], v[238:239], v[248:249], v[178:179]
  v_cvt_pk_bf16_f32 v172, v172, v173
  v_cvt_pk_bf16_f32 v173, v174, v175
  v_cvt_pk_bf16_f32 v174, v176, v177
  v_cvt_pk_bf16_f32 v175, v178, v179
  v_pk_max_i16 v172, v172, v24
  v_pk_max_i16 v173, v173, v24
  v_pk_max_i16 v174, v174, v24
  v_pk_max_i16 v175, v175, v24
  buffer_store_dwordx4 v[172:175], v18, s[32:35], s74 offen offset:256 sc1
  v_pk_mul_f32 v[152:153], v[152:153], v[250:251]
  v_pk_mul_f32 v[154:155], v[154:155], v[250:251]
  v_pk_mul_f32 v[156:157], v[156:157], v[250:251]
  v_pk_mul_f32 v[158:159], v[158:159], v[250:251]
  v_pk_fma_f32 v[152:153], v[240:241], v[246:247], v[152:153]
  v_pk_fma_f32 v[154:155], v[242:243], v[246:247], v[154:155]
  v_pk_fma_f32 v[156:157], v[20:21], v[246:247], v[156:157]
  v_pk_fma_f32 v[158:159], v[22:23], v[246:247], v[158:159]
  v_cvt_pk_bf16_f32 v152, v152, v153
  v_cvt_pk_bf16_f32 v153, v154, v155
  v_cvt_pk_bf16_f32 v154, v156, v157
  v_cvt_pk_bf16_f32 v155, v158, v159
  v_pk_max_i16 v152, v152, v24
  v_pk_max_i16 v153, v153, v24
  v_pk_max_i16 v154, v154, v24
  v_pk_max_i16 v155, v155, v24
  buffer_store_dwordx4 v[152:155], v18, s[32:35], s74 offen offset:2048 sc1
  v_pk_mul_f32 v[180:181], v[180:181], v[252:253]
  v_pk_mul_f32 v[182:183], v[182:183], v[252:253]
  v_pk_mul_f32 v[184:185], v[184:185], v[252:253]
  v_pk_mul_f32 v[186:187], v[186:187], v[252:253]
  v_pk_fma_f32 v[180:181], v[240:241], v[248:249], v[180:181]
  v_pk_fma_f32 v[182:183], v[242:243], v[248:249], v[182:183]
  v_pk_fma_f32 v[184:185], v[20:21], v[248:249], v[184:185]
  v_pk_fma_f32 v[186:187], v[22:23], v[248:249], v[186:187]
  v_cvt_pk_bf16_f32 v180, v180, v181
  v_cvt_pk_bf16_f32 v181, v182, v183
  v_cvt_pk_bf16_f32 v182, v184, v185
  v_cvt_pk_bf16_f32 v183, v186, v187
  v_pk_max_i16 v180, v180, v24
  v_pk_max_i16 v181, v181, v24
  v_pk_max_i16 v182, v182, v24
  v_pk_max_i16 v183, v183, v24
  buffer_store_dwordx4 v[180:183], v18, s[32:35], s74 offen offset:2304 sc1
  s_waitcnt lgkmcnt(12)
  ds_read_b64_tr_b16 v[224:225], v254 offset:14464
  ds_read_b64_tr_b16 v[226:227], v254 offset:16256
  v_mfma_f32_16x16x32_bf16 v[160:163], v[200:203], v[32:35], 0
  v_mfma_f32_16x16x32_bf16 v[188:191], v[200:203], v[88:91], 0
  ds_read_b64_tr_b16 v[228:229], v254 offset:14496
  ds_read_b64_tr_b16 v[230:231], v254 offset:16288
  v_mfma_f32_16x16x32_bf16 v[164:167], v[204:207], v[32:35], 0
  v_mfma_f32_16x16x32_bf16 v[192:195], v[204:207], v[88:91], 0
  s_waitcnt lgkmcnt(10)
  ds_read_b64_tr_b16 v[200:201], v254 offset:14528
  ds_read_b64_tr_b16 v[202:203], v254 offset:16320
  v_mfma_f32_16x16x32_bf16 v[168:171], v[208:211], v[32:35], 0
  v_mfma_f32_16x16x32_bf16 v[196:199], v[208:211], v[88:91], 0
  ds_read_b64_tr_b16 v[204:205], v254 offset:21632
  ds_read_b64_tr_b16 v[206:207], v254 offset:23424
  v_mfma_f32_16x16x32_bf16 v[160:163], v[212:215], v[36:39], v[160:163]
  v_mfma_f32_16x16x32_bf16 v[188:191], v[212:215], v[92:95], v[188:191]
  s_waitcnt lgkmcnt(8)
  ds_read_b64_tr_b16 v[208:209], v254 offset:21664
  ds_read_b64_tr_b16 v[210:211], v254 offset:23456
  v_mfma_f32_16x16x32_bf16 v[164:167], v[216:219], v[36:39], v[164:167]
  v_mfma_f32_16x16x32_bf16 v[192:195], v[216:219], v[92:95], v[192:195]
  ds_read_b64_tr_b16 v[212:213], v254 offset:21696
  ds_read_b64_tr_b16 v[214:215], v254 offset:23488
  v_mfma_f32_16x16x32_bf16 v[168:171], v[220:223], v[36:39], v[168:171]
  v_mfma_f32_16x16x32_bf16 v[196:199], v[220:223], v[92:95], v[196:199]
  s_waitcnt lgkmcnt(8)
  ds_read_b64_tr_b16 v[216:217], v254 offset:28800
  ds_read_b64_tr_b16 v[218:219], v254 offset:30592
  v_mfma_f32_16x16x32_bf16 v[160:163], v[224:227], v[40:43], v[160:163]
  v_mfma_f32_16x16x32_bf16 v[188:191], v[224:227], v[96:99], v[188:191]
  ds_read_b64_tr_b16 v[220:221], v254 offset:28832
  ds_read_b64_tr_b16 v[222:223], v254 offset:30624
  v_mfma_f32_16x16x32_bf16 v[164:167], v[228:231], v[40:43], v[164:167]
  v_mfma_f32_16x16x32_bf16 v[192:195], v[228:231], v[96:99], v[192:195]
  s_waitcnt lgkmcnt(8)
  ds_read_b64_tr_b16 v[224:225], v254 offset:28864
  ds_read_b64_tr_b16 v[226:227], v254 offset:30656
  v_mfma_f32_16x16x32_bf16 v[168:171], v[200:203], v[40:43], v[168:171]
  v_mfma_f32_16x16x32_bf16 v[196:199], v[200:203], v[96:99], v[196:199]
  ds_read_b64_tr_b16 v[228:229], v254 offset:35968
  ds_read_b64_tr_b16 v[230:231], v254 offset:37760
  v_mfma_f32_16x16x32_bf16 v[160:163], v[204:207], v[44:47], v[160:163]
  v_mfma_f32_16x16x32_bf16 v[188:191], v[204:207], v[100:103], v[188:191]
  s_waitcnt lgkmcnt(8)
  ds_read_b64_tr_b16 v[200:201], v254 offset:36000
  ds_read_b64_tr_b16 v[202:203], v254 offset:37792
  v_mfma_f32_16x16x32_bf16 v[164:167], v[208:211], v[44:47], v[164:167]
  v_mfma_f32_16x16x32_bf16 v[192:195], v[208:211], v[100:103], v[192:195]
  ds_read_b64_tr_b16 v[204:205], v254 offset:36032
  ds_read_b64_tr_b16 v[206:207], v254 offset:37824
  v_mfma_f32_16x16x32_bf16 v[168:171], v[212:215], v[44:47], v[168:171]
  v_mfma_f32_16x16x32_bf16 v[196:199], v[212:215], v[100:103], v[196:199]
  s_waitcnt lgkmcnt(8)
  ds_read_b64_tr_b16 v[208:209], v254 offset:43136
  ds_read_b64_tr_b16 v[210:211], v254 offset:44928
  v_mfma_f32_16x16x32_bf16 v[160:163], v[216:219], v[48:51], v[160:163]
  v_mfma_f32_16x16x32_bf16 v[188:191], v[216:219], v[104:107], v[188:191]
  ds_read_b64_tr_b16 v[212:213], v254 offset:43168
  ds_read_b64_tr_b16 v[214:215], v254 offset:44960
  v_mfma_f32_16x16x32_bf16 v[164:167], v[220:223], v[48:51], v[164:167]
  v_mfma_f32_16x16x32_bf16 v[192:195], v[220:223], v[104:107], v[192:195]
  s_waitcnt lgkmcnt(8)
  ds_read_b64_tr_b16 v[216:217], v254 offset:43200
  ds_read_b64_tr_b16 v[218:219], v254 offset:44992
  v_mfma_f32_16x16x32_bf16 v[168:171], v[224:227], v[48:51], v[168:171]
  v_mfma_f32_16x16x32_bf16 v[196:199], v[224:227], v[104:107], v[196:199]
  ds_read_b64_tr_b16 v[220:221], v254 offset:50304
  ds_read_b64_tr_b16 v[222:223], v254 offset:52096
  v_mfma_f32_16x16x32_bf16 v[160:163], v[228:231], v[52:55], v[160:163]
  v_mfma_f32_16x16x32_bf16 v[188:191], v[228:231], v[108:111], v[188:191]
  s_waitcnt lgkmcnt(8)
  ds_read_b64_tr_b16 v[224:225], v254 offset:50336
  ds_read_b64_tr_b16 v[226:227], v254 offset:52128
  v_mfma_f32_16x16x32_bf16 v[164:167], v[200:203], v[52:55], v[164:167]
  v_mfma_f32_16x16x32_bf16 v[192:195], v[200:203], v[108:111], v[192:195]
  ds_read_b64_tr_b16 v[228:229], v254 offset:50368
  ds_read_b64_tr_b16 v[230:231], v254 offset:52160
  v_mfma_f32_16x16x32_bf16 v[168:171], v[204:207], v[52:55], v[168:171]
  v_mfma_f32_16x16x32_bf16 v[196:199], v[204:207], v[108:111], v[196:199]
  s_waitcnt lgkmcnt(8)
  ds_read_b64_tr_b16 v[200:201], v255 offset:128
  ds_read_b64_tr_b16 v[202:203], v255 offset:1920
  v_mfma_f32_16x16x32_bf16 v[160:163], v[208:211], v[56:59], v[160:163]
  v_mfma_f32_16x16x32_bf16 v[188:191], v[208:211], v[112:115], v[188:191]
  ds_read_b64_tr_b16 v[204:205], v255 offset:160
  ds_read_b64_tr_b16 v[206:207], v255 offset:1952
  v_mfma_f32_16x16x32_bf16 v[164:167], v[212:215], v[56:59], v[164:167]
  v_mfma_f32_16x16x32_bf16 v[192:195], v[212:215], v[112:115], v[192:195]
  s_waitcnt lgkmcnt(8)
  ds_read_b64_tr_b16 v[208:209], v255 offset:192
  ds_read_b64_tr_b16 v[210:211], v255 offset:1984
  v_mfma_f32_16x16x32_bf16 v[168:171], v[216:219], v[56:59], v[168:171]
  v_mfma_f32_16x16x32_bf16 v[196:199], v[216:219], v[112:115], v[196:199]
  ds_read_b64_tr_b16 v[212:213], v255 offset:7296
  ds_read_b64_tr_b16 v[214:215], v255 offset:9088
  v_mfma_f32_16x16x32_bf16 v[160:163], v[220:223], v[60:63], v[160:163]
  v_mfma_f32_16x16x32_bf16 v[188:191], v[220:223], v[116:119], v[188:191]
  s_waitcnt lgkmcnt(8)
  ds_read_b64_tr_b16 v[216:217], v255 offset:7328
  ds_read_b64_tr_b16 v[218:219], v255 offset:9120
  v_mfma_f32_16x16x32_bf16 v[164:167], v[224:227], v[60:63], v[164:167]
  v_mfma_f32_16x16x32_bf16 v[192:195], v[224:227], v[116:119], v[192:195]
  ds_read_b64_tr_b16 v[220:221], v255 offset:7360
  ds_read_b64_tr_b16 v[222:223], v255 offset:9152
  v_mfma_f32_16x16x32_bf16 v[168:171], v[228:231], v[60:63], v[168:171]
  v_mfma_f32_16x16x32_bf16 v[196:199], v[228:231], v[116:119], v[196:199]
  s_waitcnt lgkmcnt(8)
  ds_read_b64_tr_b16 v[224:225], v255 offset:14464
  ds_read_b64_tr_b16 v[226:227], v255 offset:16256
  v_mfma_f32_16x16x32_bf16 v[160:163], v[200:203], v[64:67], v[160:163]
  v_mfma_f32_16x16x32_bf16 v[188:191], v[200:203], v[120:123], v[188:191]
  ds_read_b64_tr_b16 v[228:229], v255 offset:14496
  ds_read_b64_tr_b16 v[230:231], v255 offset:16288
  v_mfma_f32_16x16x32_bf16 v[164:167], v[204:207], v[64:67], v[164:167]
  v_mfma_f32_16x16x32_bf16 v[192:195], v[204:207], v[120:123], v[192:195]
  s_waitcnt lgkmcnt(8)
  ds_read_b64_tr_b16 v[200:201], v255 offset:14528
  ds_read_b64_tr_b16 v[202:203], v255 offset:16320
  v_mfma_f32_16x16x32_bf16 v[168:171], v[208:211], v[64:67], v[168:171]
  v_mfma_f32_16x16x32_bf16 v[196:199], v[208:211], v[120:123], v[196:199]
  ds_read_b64_tr_b16 v[204:205], v255 offset:21632
  ds_read_b64_tr_b16 v[206:207], v255 offset:23424
  v_mfma_f32_16x16x32_bf16 v[160:163], v[212:215], v[68:71], v[160:163]
  v_mfma_f32_16x16x32_bf16 v[188:191], v[212:215], v[124:127], v[188:191]
  s_waitcnt lgkmcnt(8)
  ds_read_b64_tr_b16 v[208:209], v255 offset:21664
  ds_read_b64_tr_b16 v[210:211], v255 offset:23456
  v_mfma_f32_16x16x32_bf16 v[164:167], v[216:219], v[68:71], v[164:167]
  v_mfma_f32_16x16x32_bf16 v[192:195], v[216:219], v[124:127], v[192:195]
  ds_read_b64_tr_b16 v[212:213], v255 offset:21696
  ds_read_b64_tr_b16 v[214:215], v255 offset:23488
  v_mfma_f32_16x16x32_bf16 v[168:171], v[220:223], v[68:71], v[168:171]
  v_mfma_f32_16x16x32_bf16 v[196:199], v[220:223], v[124:127], v[196:199]
  s_waitcnt lgkmcnt(8)
  ds_read_b64_tr_b16 v[216:217], v27 offset:128
  ds_read_b64_tr_b16 v[218:219], v27 offset:1920
  v_mfma_f32_16x16x32_bf16 v[160:163], v[224:227], v[72:75], v[160:163]
  v_mfma_f32_16x16x32_bf16 v[188:191], v[224:227], v[128:131], v[188:191]
  ds_read_b64_tr_b16 v[220:221], v27 offset:160
  ds_read_b64_tr_b16 v[222:223], v27 offset:1952
  v_mfma_f32_16x16x32_bf16 v[164:167], v[228:231], v[72:75], v[164:167]
  v_mfma_f32_16x16x32_bf16 v[192:195], v[228:231], v[128:131], v[192:195]
  s_waitcnt lgkmcnt(8)
  ds_read_b64_tr_b16 v[224:225], v27 offset:192
  ds_read_b64_tr_b16 v[226:227], v27 offset:1984
  v_mfma_f32_16x16x32_bf16 v[168:171], v[200:203], v[72:75], v[168:171]
  v_mfma_f32_16x16x32_bf16 v[196:199], v[200:203], v[128:131], v[196:199]
  ds_read_b64_tr_b16 v[228:229], v27 offset:7296
  ds_read_b64_tr_b16 v[230:231], v27 offset:9088
  v_mfma_f32_16x16x32_bf16 v[160:163], v[204:207], v[76:79], v[160:163]
  v_mfma_f32_16x16x32_bf16 v[188:191], v[204:207], v[132:135], v[188:191]
  s_waitcnt lgkmcnt(8)
  ds_read_b64_tr_b16 v[200:201], v27 offset:7328
  ds_read_b64_tr_b16 v[202:203], v27 offset:9120
  v_mfma_f32_16x16x32_bf16 v[164:167], v[208:211], v[76:79], v[164:167]
  v_mfma_f32_16x16x32_bf16 v[192:195], v[208:211], v[132:135], v[192:195]
  ds_read_b64_tr_b16 v[204:205], v27 offset:7360
  ds_read_b64_tr_b16 v[206:207], v27 offset:9152
  v_mfma_f32_16x16x32_bf16 v[168:171], v[212:215], v[76:79], v[168:171]
  v_mfma_f32_16x16x32_bf16 v[196:199], v[212:215], v[132:135], v[196:199]
  s_waitcnt lgkmcnt(8)
  v_mfma_f32_16x16x32_bf16 v[160:163], v[216:219], v[80:83], v[160:163]
  v_mfma_f32_16x16x32_bf16 v[188:191], v[216:219], v[136:139], v[188:191]
  v_mfma_f32_16x16x32_bf16 v[164:167], v[220:223], v[80:83], v[164:167]
  v_mfma_f32_16x16x32_bf16 v[192:195], v[220:223], v[136:139], v[192:195]
  s_waitcnt lgkmcnt(4)
  ds_read_b128 v[232:235], v7 offset:256
  ds_read_b128 v[236:239], v7 offset:320
  ds_read_b128 v[240:243], v7 offset:384
  v_mfma_f32_16x16x32_bf16 v[168:171], v[224:227], v[80:83], v[168:171]
  v_mfma_f32_16x16x32_bf16 v[196:199], v[224:227], v[136:139], v[196:199]
  v_mfma_f32_16x16x32_bf16 v[160:163], v[228:231], v[84:87], v[160:163]
  v_mfma_f32_16x16x32_bf16 v[188:191], v[228:231], v[140:143], v[188:191]
  s_waitcnt lgkmcnt(3)
  v_mfma_f32_16x16x32_bf16 v[164:167], v[200:203], v[84:87], v[164:167]
  v_mfma_f32_16x16x32_bf16 v[192:195], v[200:203], v[140:143], v[192:195]
  v_mfma_f32_16x16x32_bf16 v[168:171], v[204:207], v[84:87], v[168:171]
  v_mfma_f32_16x16x32_bf16 v[196:199], v[204:207], v[140:143], v[196:199]
  s_waitcnt lgkmcnt(0)
  s_nop 0
  v_pk_mul_f32 v[160:161], v[160:161], v[250:251]
  v_pk_mul_f32 v[162:163], v[162:163], v[250:251]
  s_nop 0
  v_pk_mul_f32 v[164:165], v[164:165], v[250:251]
  v_pk_mul_f32 v[166:167], v[166:167], v[250:251]
  v_pk_fma_f32 v[160:161], v[232:233], v[246:247], v[160:161]
  v_pk_fma_f32 v[162:163], v[234:235], v[246:247], v[162:163]
  v_pk_fma_f32 v[164:165], v[236:237], v[246:247], v[164:165]
  v_pk_fma_f32 v[166:167], v[238:239], v[246:247], v[166:167]
  v_cvt_pk_bf16_f32 v160, v160, v161
  v_cvt_pk_bf16_f32 v161, v162, v163
  v_cvt_pk_bf16_f32 v162, v164, v165
  v_cvt_pk_bf16_f32 v163, v166, v167
  v_pk_max_i16 v160, v160, v24
  v_pk_max_i16 v161, v161, v24
  v_pk_max_i16 v162, v162, v24
  v_pk_max_i16 v163, v163, v24
  buffer_store_dwordx4 v[160:163], v18, s[32:35], s75 offen offset:0 sc1
  v_pk_mul_f32 v[188:189], v[188:189], v[252:253]
  v_pk_mul_f32 v[190:191], v[190:191], v[252:253]
  v_pk_mul_f32 v[192:193], v[192:193], v[252:253]
  v_pk_mul_f32 v[194:195], v[194:195], v[252:253]
  v_pk_fma_f32 v[188:189], v[232:233], v[248:249], v[188:189]
  v_pk_fma_f32 v[190:191], v[234:235], v[248:249], v[190:191]
  v_pk_fma_f32 v[192:193], v[236:237], v[248:249], v[192:193]
  v_pk_fma_f32 v[194:195], v[238:239], v[248:249], v[194:195]
  v_cvt_pk_bf16_f32 v188, v188, v189
  v_cvt_pk_bf16_f32 v189, v190, v191
  v_cvt_pk_bf16_f32 v190, v192, v193
  v_cvt_pk_bf16_f32 v191, v194, v195
  v_pk_max_i16 v188, v188, v24
  v_pk_max_i16 v189, v189, v24
  v_pk_max_i16 v190, v190, v24
  v_pk_max_i16 v191, v191, v24
  buffer_store_dwordx4 v[188:191], v18, s[32:35], s75 offen offset:256 sc1
  v_pk_mul_f32 v[168:169], v[168:169], v[250:251]
  v_pk_mul_f32 v[170:171], v[170:171], v[250:251]
  v_pk_fma_f32 v[168:169], v[240:241], v[246:247], v[168:169]
  v_pk_fma_f32 v[170:171], v[242:243], v[246:247], v[170:171]
  v_cvt_pk_bf16_f32 v168, v168, v169
  v_cvt_pk_bf16_f32 v169, v170, v171
  v_pk_max_i16 v168, v168, v24
  v_pk_max_i16 v169, v169, v24
  buffer_store_dwordx2 v[168:169], v19, s[32:35], s75 offen offset:2048 sc1
  v_pk_mul_f32 v[196:197], v[196:197], v[252:253]
  v_pk_mul_f32 v[198:199], v[198:199], v[252:253]
  v_pk_fma_f32 v[196:197], v[240:241], v[248:249], v[196:197]
  v_pk_fma_f32 v[198:199], v[242:243], v[248:249], v[198:199]
  v_cvt_pk_bf16_f32 v196, v196, v197
  v_cvt_pk_bf16_f32 v197, v198, v199
  v_pk_max_i16 v196, v196, v24
  v_pk_max_i16 v197, v197, v24
  buffer_store_dwordx2 v[196:197], v19, s[32:35], s75 offen offset:2304 sc1
  s_mul_i32 s60, s48, 14336
  v_lshrrev_b32 v18, 2, v4
  v_lshrrev_b32 v19, 1, v18
  v_xor_b32 v19, s48, v19
  v_lshl_add_u32 v18, v3, 2, v18
  v_lshlrev_b32 v18, 7, v18
  v_bfe_u32 v20, v1, 4, 1
  v_lshl_add_u32 v18, v20, 5, v18
  v_and_b32 v20, 3, v1
  v_lshl_add_u32 v18, v20, 3, v18
  v_add_u32 v18, s60, v18
  v_lshl_add_u32 v208, v19, 6, v18
  v_xor_b32 v209, 64, v208
  v_add_u32 v210, 57344, v208
  v_add_u32 v211, 57344, v209
  v_add_u32 v212, 86016, v208
  v_add_u32 v213, 86016, v209
  v_lshrrev_b32 v18, 2, v4
  v_lshrrev_b32 v19, 1, v18
  v_xor_b32 v19, s48, v19
  v_lshl_add_u32 v18, v3, 3, v18
  v_lshlrev_b32 v18, 7, v18
  v_bfe_u32 v20, v1, 4, 1
  v_lshl_add_u32 v18, v20, 5, v18
  v_and_b32 v20, 3, v1
  v_lshl_add_u32 v18, v20, 3, v18
  v_add_u32 v18, s60, v18
  v_lshl_add_u32 v214, v19, 6, v18
  v_xor_b32 v215, 64, v214
  v_add_u32 v216, 57344, v214
  v_add_u32 v217, 57344, v215
  v_add_u32 v218, 86016, v214
  v_add_u32 v219, 86016, v215
  v_add_u32 v162, s57, v6
  v_xor_b32 v163, 0x2000, v162
  v_add_u32 v162, 144384, v162
  v_add_u32 v163, 144384, v163
  v_lshlrev_b32 v168, 16, v8
  v_and_b32 v169, 0xffff0000, v8
  v_lshlrev_b32 v170, 16, v9
  v_and_b32 v171, 0xffff0000, v9
  v_lshlrev_b32 v172, 16, v10
  v_and_b32 v173, 0xffff0000, v10
  v_lshlrev_b32 v174, 16, v11
  v_and_b32 v175, 0xffff0000, v11
  v_lshlrev_b32 v176, 16, v12
  v_and_b32 v177, 0xffff0000, v12
  v_lshlrev_b32 v178, 16, v13
  v_and_b32 v179, 0xffff0000, v13
  v_lshlrev_b32 v180, 16, v14
  v_and_b32 v181, 0xffff0000, v14
  v_lshlrev_b32 v182, 16, v15
  v_and_b32 v183, 0xffff0000, v15
  s_mul_i32 s60, s49, 4608
  s_lshl_b32 s65, s48, 6
  s_add_u32 s60, s60, s65
  v_mul_u32_u24 v184, 144, v2
  v_lshl_add_u32 v184, v3, 4, v184
  v_add_u32 v184, s60, v184
  v_lshrrev_b32 v18, 3, v1
  v_and_b32 v19, 7, v1
  v_mul_u32_u24 v185, 144, v18
  v_lshl_add_u32 v185, v19, 4, v185
  s_mul_i32 s60, s45, 2304
  v_add_u32 v185, s60, v185
  v_mul_u32_u24 v186, 896, v18
  v_lshl_add_u32 v186, v19, 4, v186
  s_mul_i32 s74, s36, 114688
  s_mul_i32 s65, s46, 57344
  s_add_u32 s74, s74, s65
  s_mul_i32 s65, s45, 14336
  s_add_u32 s74, s74, s65
  s_lshl_b32 s65, s47, 7
  s_add_u32 s74, s74, s65
  s_add_u32 s75, s74, 7168
  s_lshl_b32 s60, s72, 7
  s_lshl_b32 s65, s48, 6
  s_add_u32 s60, s60, s65
  s_add_u32 s60, s60, 18022400
  v_and_b32 v18, 7, v1
  v_lshlrev_b32 v18, 3, v18
  v_add_u32 v18, s60, v18
  s_mul_i32 s64, s72, 114688
  s_mul_i32 s65, s48, 57344
  s_add_u32 s64, s64, s65
  s_add_u32 s64, s64, 10485760
  s_cmp_eq_u32 s41, 0
  s_cbranch_scc1 Lslow_22
  s_waitcnt vmcnt(0)
  s_mov_b64 exec, 1
  buffer_store_dwordx2 v[16:17], v24, s[32:35], s79 offen
  s_mov_b64 exec, -1
  s_branch Lpub_23
Lslow_22:
  s_waitcnt vmcnt(0)
  s_mov_b64 exec, 1
  buffer_store_dwordx2 v[16:17], v24, s[32:35], s79 offen sc1
  s_mov_b64 exec, -1
Lpub_23:
  s_cmp_ge_u32 s37, 14
  s_cbranch_scc1 Lend
  s_barrier
  ds_read_b64_tr_b16 v[128:129], v212 offset:0
  ds_read_b64_tr_b16 v[130:131], v212 offset:2048
  ds_read_b64_tr_b16 v[132:133], v213 offset:0
  ds_read_b64_tr_b16 v[134:135], v213 offset:2048
  ds_read_b64_tr_b16 v[136:137], v212 offset:1024
  ds_read_b64_tr_b16 v[138:139], v212 offset:3072
  ds_read_b64_tr_b16 v[140:141], v213 offset:1024
  ds_read_b64_tr_b16 v[142:143], v213 offset:3072
  ds_read_b64_tr_b16 v[144:145], v212 offset:4096
  ds_read_b64_tr_b16 v[146:147], v212 offset:6144
  ds_read_b64_tr_b16 v[148:149], v213 offset:4096
  ds_read_b64_tr_b16 v[150:151], v213 offset:6144
  s_mov_b32 s58, 0x20000
Lpoll_f4_24:
  buffer_load_dwordx2 v[20:21], v18, s[32:35], 0 offen sc1
  s_sub_u32 s58, s58, 1
  s_waitcnt vmcnt(0)
  v_and_b32 v20, -8, v20
  v_cmp_ne_u64 vcc, s[42:43], v[20:21]
  s_cmp_eq_u32 s58, 0
  s_nop 3
  s_cbranch_scc1 Lpolld_f4_25
  s_cbranch_vccnz Lpoll_f4_24
Lpolld_f4_25:
  s_add_u32 s60, s88, 0
  s_and_b32 s60, s60, 7
  s_mul_i32 s60, s60, 7168
  s_add_u32 s63, s64, s60
  buffer_load_dwordx4 v[64:67], v6, s[32:35], s63 offen offset:0 sc1
  buffer_load_dwordx4 v[68:71], v6, s[32:35], s63 offen offset:1024 sc1
  buffer_load_dwordx4 v[72:75], v6, s[32:35], s63 offen offset:2048 sc1
  buffer_load_dwordx4 v[76:79], v6, s[32:35], s63 offen offset:3072 sc1
  s_add_u32 s63, s63, 4096
  buffer_load_dwordx4 v[80:83], v6, s[32:35], s63 offen offset:0 sc1
  buffer_load_dwordx4 v[84:87], v6, s[32:35], s63 offen offset:1024 sc1
  buffer_load_dwordx4 v[88:91], v6, s[32:35], s63 offen offset:2048 sc1
  s_add_u32 s60, s88, 1
  s_and_b32 s60, s60, 7
  s_mul_i32 s60, s60, 7168
  s_add_u32 s63, s64, s60
  buffer_load_dwordx4 v[92:95], v6, s[32:35], s63 offen offset:0 sc1
  s_waitcnt vmcnt(7) lgkmcnt(8)
  ds_read_b64_tr_b16 v[152:153], v212 offset:5120
  ds_read_b64_tr_b16 v[154:155], v212 offset:7168
  ds_read_b64_tr_b16 v[156:157], v213 offset:5120
  ds_read_b64_tr_b16 v[158:159], v213 offset:7168
  v_mfma_f32_32x32x16_bf16 v[48:63], v[132:135], v[64:67], 0
  buffer_load_dwordx4 v[96:99], v6, s[32:35], s63 offen offset:1024 sc1
  v_mfma_f32_32x32x16_bf16 v[32:47], v[128:131], v[64:67], 0
  s_waitcnt vmcnt(7) lgkmcnt(8)
  ds_read_b64_tr_b16 v[128:129], v212 offset:8192
  ds_read_b64_tr_b16 v[130:131], v212 offset:10240
  ds_read_b64_tr_b16 v[132:133], v213 offset:8192
  ds_read_b64_tr_b16 v[134:135], v213 offset:10240
  v_mfma_f32_32x32x16_bf16 v[48:63], v[140:143], v[68:71], v[48:63]
  buffer_load_dwordx4 v[100:103], v6, s[32:35], s63 offen offset:2048 sc1
  v_mfma_f32_32x32x16_bf16 v[32:47], v[136:139], v[68:71], v[32:47]
  s_waitcnt vmcnt(7) lgkmcnt(8)
  ds_read_b64_tr_b16 v[136:137], v212 offset:9216
  ds_read_b64_tr_b16 v[138:139], v212 offset:11264
  ds_read_b64_tr_b16 v[140:141], v213 offset:9216
  ds_read_b64_tr_b16 v[142:143], v213 offset:11264
  v_mfma_f32_32x32x16_bf16 v[48:63], v[148:151], v[72:75], v[48:63]
  buffer_load_dwordx4 v[104:107], v6, s[32:35], s63 offen offset:3072 sc1
  v_mfma_f32_32x32x16_bf16 v[32:47], v[144:147], v[72:75], v[32:47]
  s_waitcnt vmcnt(7) lgkmcnt(8)
  ds_read_b64_tr_b16 v[144:145], v218 offset:12288
  ds_read_b64_tr_b16 v[146:147], v218 offset:12800
  ds_read_b64_tr_b16 v[148:149], v219 offset:12288
  ds_read_b64_tr_b16 v[150:151], v219 offset:12800
  v_mfma_f32_32x32x16_bf16 v[48:63], v[156:159], v[76:79], v[48:63]
  s_add_u32 s63, s63, 4096
  buffer_load_dwordx4 v[108:111], v6, s[32:35], s63 offen offset:0 sc1
  v_mfma_f32_32x32x16_bf16 v[32:47], v[152:155], v[76:79], v[32:47]
  s_waitcnt vmcnt(7) lgkmcnt(8)
  ds_read_b64_tr_b16 v[152:153], v212 offset:28672
  ds_read_b64_tr_b16 v[154:155], v212 offset:30720
  ds_read_b64_tr_b16 v[156:157], v213 offset:28672
  ds_read_b64_tr_b16 v[158:159], v213 offset:30720
  v_mfma_f32_32x32x16_bf16 v[48:63], v[132:135], v[80:83], v[48:63]
  buffer_load_dwordx4 v[112:115], v6, s[32:35], s63 offen offset:1024 sc1
  v_mfma_f32_32x32x16_bf16 v[32:47], v[128:131], v[80:83], v[32:47]
  s_waitcnt vmcnt(7) lgkmcnt(8)
  ds_read_b64_tr_b16 v[128:129], v212 offset:29696
  ds_read_b64_tr_b16 v[130:131], v212 offset:31744
  ds_read_b64_tr_b16 v[132:133], v213 offset:29696
  ds_read_b64_tr_b16 v[134:135], v213 offset:31744
  v_mfma_f32_32x32x16_bf16 v[48:63], v[140:143], v[84:87], v[48:63]
  buffer_load_dwordx4 v[116:119], v6, s[32:35], s63 offen offset:2048 sc1
  v_mfma_f32_32x32x16_bf16 v[32:47], v[136:139], v[84:87], v[32:47]
  s_waitcnt vmcnt(7) lgkmcnt(8)
  ds_read_b64_tr_b16 v[136:137], v212 offset:32768
  ds_read_b64_tr_b16 v[138:139], v212 offset:34816
  ds_read_b64_tr_b16 v[140:141], v213 offset:32768
  ds_read_b64_tr_b16 v[142:143], v213 offset:34816
  v_mfma_f32_32x32x16_bf16 v[48:63], v[148:151], v[88:91], v[48:63]
  s_add_u32 s60, s88, 2
  s_and_b32 s60, s60, 7
  s_mul_i32 s60, s60, 7168
  s_add_u32 s63, s64, s60
  buffer_load_dwordx4 v[120:123], v6, s[32:35], s63 offen offset:0 sc1
  v_mfma_f32_32x32x16_bf16 v[32:47], v[144:147], v[88:91], v[32:47]
  s_waitcnt vmcnt(7) lgkmcnt(8)
  ds_read_b64_tr_b16 v[144:145], v212 offset:33792
  ds_read_b64_tr_b16 v[146:147], v212 offset:35840
  ds_read_b64_tr_b16 v[148:149], v213 offset:33792
  ds_read_b64_tr_b16 v[150:151], v213 offset:35840
  v_mfma_f32_32x32x16_bf16 v[48:63], v[156:159], v[92:95], v[48:63]
  buffer_load_dwordx4 v[124:127], v6, s[32:35], s63 offen offset:1024 sc1
  v_mfma_f32_32x32x16_bf16 v[32:47], v[152:155], v[92:95], v[32:47]
  s_waitcnt vmcnt(7) lgkmcnt(8)
  ds_read_b64_tr_b16 v[152:153], v212 offset:36864
  ds_read_b64_tr_b16 v[154:155], v212 offset:38912
  ds_read_b64_tr_b16 v[156:157], v213 offset:36864
  ds_read_b64_tr_b16 v[158:159], v213 offset:38912
  v_mfma_f32_32x32x16_bf16 v[48:63], v[132:135], v[96:99], v[48:63]
  buffer_load_dwordx4 v[64:67], v6, s[32:35], s63 offen offset:2048 sc1
  v_mfma_f32_32x32x16_bf16 v[32:47], v[128:131], v[96:99], v[32:47]
  s_waitcnt vmcnt(7) lgkmcnt(8)
  ds_read_b64_tr_b16 v[128:129], v212 offset:37888
  ds_read_b64_tr_b16 v[130:131], v212 offset:39936
  ds_read_b64_tr_b16 v[132:133], v213 offset:37888
  ds_read_b64_tr_b16 v[134:135], v213 offset:39936
  v_mfma_f32_32x32x16_bf16 v[48:63], v[140:143], v[100:103], v[48:63]
  buffer_load_dwordx4 v[68:71], v6, s[32:35], s63 offen offset:3072 sc1
  v_mfma_f32_32x32x16_bf16 v[32:47], v[136:139], v[100:103], v[32:47]
  s_waitcnt vmcnt(7) lgkmcnt(8)
  ds_read_b64_tr_b16 v[136:137], v218 offset:40960
  ds_read_b64_tr_b16 v[138:139], v218 offset:41472
  ds_read_b64_tr_b16 v[140:141], v219 offset:40960
  ds_read_b64_tr_b16 v[142:143], v219 offset:41472
  v_mfma_f32_32x32x16_bf16 v[48:63], v[148:151], v[104:107], v[48:63]
  s_add_u32 s63, s63, 4096
  buffer_load_dwordx4 v[72:75], v6, s[32:35], s63 offen offset:0 sc1
  v_mfma_f32_32x32x16_bf16 v[32:47], v[144:147], v[104:107], v[32:47]
  s_waitcnt vmcnt(7) lgkmcnt(8)
  v_mfma_f32_32x32x16_bf16 v[48:63], v[156:159], v[108:111], v[48:63]
  buffer_load_dwordx4 v[76:79], v6, s[32:35], s63 offen offset:1024 sc1
  v_mfma_f32_32x32x16_bf16 v[32:47], v[152:155], v[108:111], v[32:47]
  s_waitcnt vmcnt(7) lgkmcnt(4)
  v_mfma_f32_32x32x16_bf16 v[48:63], v[132:135], v[112:115], v[48:63]
  buffer_load_dwordx4 v[80:83], v6, s[32:35], s63 offen offset:2048 sc1
  v_mfma_f32_32x32x16_bf16 v[32:47], v[128:131], v[112:115], v[32:47]
  s_waitcnt vmcnt(7) lgkmcnt(0)
  v_mfma_f32_32x32x16_bf16 v[48:63], v[140:143], v[116:119], v[48:63]
  s_add_u32 s60, s88, 3
  s_and_b32 s60, s60, 7
  s_mul_i32 s60, s60, 7168
  s_add_u32 s63, s64, s60
  buffer_load_dwordx4 v[84:87], v6, s[32:35], s63 offen offset:0 sc1
  v_mfma_f32_32x32x16_bf16 v[32:47], v[136:139], v[116:119], v[32:47]
  s_barrier
  ds_read_b64_tr_b16 v[144:145], v208 offset:0
  ds_read_b64_tr_b16 v[146:147], v208 offset:2048
  ds_read_b64_tr_b16 v[148:149], v209 offset:0
  ds_read_b64_tr_b16 v[150:151], v209 offset:2048
  ds_read_b64_tr_b16 v[152:153], v208 offset:1024
  ds_read_b64_tr_b16 v[154:155], v208 offset:3072
  ds_read_b64_tr_b16 v[156:157], v209 offset:1024
  ds_read_b64_tr_b16 v[158:159], v209 offset:3072
  ds_read_b64_tr_b16 v[128:129], v208 offset:4096
  ds_read_b64_tr_b16 v[130:131], v208 offset:6144
  ds_read_b64_tr_b16 v[132:133], v209 offset:4096
  ds_read_b64_tr_b16 v[134:135], v209 offset:6144
  s_waitcnt vmcnt(7) lgkmcnt(8)
  ds_read_b64_tr_b16 v[136:137], v208 offset:5120
  ds_read_b64_tr_b16 v[138:139], v208 offset:7168
  ds_read_b64_tr_b16 v[140:141], v209 offset:5120
  ds_read_b64_tr_b16 v[142:143], v209 offset:7168
  v_mfma_f32_32x32x16_bf16 v[48:63], v[148:151], v[120:123], v[48:63]
  buffer_load_dwordx4 v[88:91], v6, s[32:35], s63 offen offset:1024 sc1
  v_mfma_f32_32x32x16_bf16 v[32:47], v[144:147], v[120:123], v[32:47]
  s_waitcnt vmcnt(7) lgkmcnt(8)
  ds_read_b64_tr_b16 v[144:145], v208 offset:8192
  ds_read_b64_tr_b16 v[146:147], v208 offset:10240
  ds_read_b64_tr_b16 v[148:149], v209 offset:8192
  ds_read_b64_tr_b16 v[150:151], v209 offset:10240
  v_mfma_f32_32x32x16_bf16 v[48:63], v[156:159], v[124:127], v[48:63]
  buffer_load_dwordx4 v[92:95], v6, s[32:35], s63 offen offset:2048 sc1
  v_mfma_f32_32x32x16_bf16 v[32:47], v[152:155], v[124:127], v[32:47]
  s_waitcnt vmcnt(7) lgkmcnt(8)
  ds_read_b64_tr_b16 v[152:153], v208 offset:9216
  ds_read_b64_tr_b16 v[154:155], v208 offset:11264
  ds_read_b64_tr_b16 v[156:157], v209 offset:9216
  ds_read_b64_tr_b16 v[158:159], v209 offset:11264
  v_mfma_f32_32x32x16_bf16 v[48:63], v[132:135], v[64:67], v[48:63]
  buffer_load_dwordx4 v[96:99], v6, s[32:35], s63 offen offset:3072 sc1
  v_mfma_f32_32x32x16_bf16 v[32:47], v[128:131], v[64:67], v[32:47]
  s_waitcnt vmcnt(7) lgkmcnt(8)
  ds_read_b64_tr_b16 v[128:129], v214 offset:12288
  ds_read_b64_tr_b16 v[130:131], v214 offset:12800
  ds_read_b64_tr_b16 v[132:133], v215 offset:12288
  ds_read_b64_tr_b16 v[134:135], v215 offset:12800
  v_mfma_f32_32x32x16_bf16 v[48:63], v[140:143], v[68:71], v[48:63]
  s_add_u32 s63, s63, 4096
  buffer_load_dwordx4 v[100:103], v6, s[32:35], s63 offen offset:0 sc1
  v_mfma_f32_32x32x16_bf16 v[32:47], v[136:139], v[68:71], v[32:47]
  s_waitcnt vmcnt(7) lgkmcnt(8)
  ds_read_b64_tr_b16 v[136:137], v208 offset:28672
  ds_read_b64_tr_b16 v[138:139], v208 offset:30720
  ds_read_b64_tr_b16 v[140:141], v209 offset:28672
  ds_read_b64_tr_b16 v[142:143], v209 offset:30720
  v_mfma_f32_32x32x16_bf16 v[48:63], v[148:151], v[72:75], v[48:63]
  buffer_load_dwordx4 v[104:107], v6, s[32:35], s63 offen offset:1024 sc1
  v_mfma_f32_32x32x16_bf16 v[32:47], v[144:147], v[72:75], v[32:47]
  s_waitcnt vmcnt(7) lgkmcnt(8)
  ds_read_b64_tr_b16 v[144:145], v208 offset:29696
  ds_read_b64_tr_b16 v[146:147], v208 offset:31744
  ds_read_b64_tr_b16 v[148:149], v209 offset:29696
  ds_read_b64_tr_b16 v[150:151], v209 offset:31744
  v_mfma_f32_32x32x16_bf16 v[48:63], v[156:159], v[76:79], v[48:63]
  buffer_load_dwordx4 v[108:111], v6, s[32:35], s63 offen offset:2048 sc1
  v_mfma_f32_32x32x16_bf16 v[32:47], v[152:155], v[76:79], v[32:47]
  s_waitcnt vmcnt(7) lgkmcnt(8)
  ds_read_b64_tr_b16 v[152:153], v208 offset:32768
  ds_read_b64_tr_b16 v[154:155], v208 offset:34816
  ds_read_b64_tr_b16 v[156:157], v209 offset:32768
  ds_read_b64_tr_b16 v[158:159], v209 offset:34816
  v_mfma_f32_32x32x16_bf16 v[48:63], v[132:135], v[80:83], v[48:63]
  s_add_u32 s60, s88, 4
  s_and_b32 s60, s60, 7
  s_mul_i32 s60, s60, 7168
  s_add_u32 s63, s64, s60
  buffer_load_dwordx4 v[112:115], v6, s[32:35], s63 offen offset:0 sc1
  v_mfma_f32_32x32x16_bf16 v[32:47], v[128:131], v[80:83], v[32:47]
  s_waitcnt vmcnt(7) lgkmcnt(8)
  ds_read_b64_tr_b16 v[128:129], v208 offset:33792
  ds_read_b64_tr_b16 v[130:131], v208 offset:35840
  ds_read_b64_tr_b16 v[132:133], v209 offset:33792
  ds_read_b64_tr_b16 v[134:135], v209 offset:35840
  v_mfma_f32_32x32x16_bf16 v[48:63], v[140:143], v[84:87], v[48:63]
  buffer_load_dwordx4 v[116:119], v6, s[32:35], s63 offen offset:1024 sc1
  v_mfma_f32_32x32x16_bf16 v[32:47], v[136:139], v[84:87], v[32:47]
  s_waitcnt vmcnt(7) lgkmcnt(8)
  ds_read_b64_tr_b16 v[136:137], v208 offset:36864
  ds_read_b64_tr_b16 v[138:139], v208 offset:38912
  ds_read_b64_tr_b16 v[140:141], v209 offset:36864
  ds_read_b64_tr_b16 v[142:143], v209 offset:38912
  v_mfma_f32_32x32x16_bf16 v[48:63], v[148:151], v[88:91], v[48:63]
  buffer_load_dwordx4 v[120:123], v6, s[32:35], s63 offen offset:2048 sc1
  v_mfma_f32_32x32x16_bf16 v[32:47], v[144:147], v[88:91], v[32:47]
  s_waitcnt vmcnt(7) lgkmcnt(8)
  ds_read_b64_tr_b16 v[144:145], v208 offset:37888
  ds_read_b64_tr_b16 v[146:147], v208 offset:39936
  ds_read_b64_tr_b16 v[148:149], v209 offset:37888
  ds_read_b64_tr_b16 v[150:151], v209 offset:39936
  v_mfma_f32_32x32x16_bf16 v[48:63], v[156:159], v[92:95], v[48:63]
  buffer_load_dwordx4 v[124:127], v6, s[32:35], s63 offen offset:3072 sc1
  v_mfma_f32_32x32x16_bf16 v[32:47], v[152:155], v[92:95], v[32:47]
  s_waitcnt vmcnt(7) lgkmcnt(8)
  ds_read_b64_tr_b16 v[152:153], v214 offset:40960
  ds_read_b64_tr_b16 v[154:155], v214 offset:41472
  ds_read_b64_tr_b16 v[156:157], v215 offset:40960
  ds_read_b64_tr_b16 v[158:159], v215 offset:41472
  v_mfma_f32_32x32x16_bf16 v[48:63], v[132:135], v[96:99], v[48:63]
  s_add_u32 s63, s63, 4096
  buffer_load_dwordx4 v[64:67], v6, s[32:35], s63 offen offset:0 sc1
  v_mfma_f32_32x32x16_bf16 v[32:47], v[128:131], v[96:99], v[32:47]
  s_waitcnt vmcnt(7) lgkmcnt(8)
  v_mfma_f32_32x32x16_bf16 v[48:63], v[140:143], v[100:103], v[48:63]
  buffer_load_dwordx4 v[68:71], v6, s[32:35], s63 offen offset:1024 sc1
  v_mfma_f32_32x32x16_bf16 v[32:47], v[136:139], v[100:103], v[32:47]
  s_waitcnt vmcnt(7) lgkmcnt(4)
  v_mfma_f32_32x32x16_bf16 v[48:63], v[148:151], v[104:107], v[48:63]
  buffer_load_dwordx4 v[72:75], v6, s[32:35], s63 offen offset:2048 sc1
  v_mfma_f32_32x32x16_bf16 v[32:47], v[144:147], v[104:107], v[32:47]
  s_waitcnt vmcnt(7) lgkmcnt(0)
  v_mfma_f32_32x32x16_bf16 v[48:63], v[156:159], v[108:111], v[48:63]
  s_add_u32 s60, s88, 5
  s_and_b32 s60, s60, 7
  s_mul_i32 s60, s60, 7168
  s_add_u32 s63, s64, s60
  buffer_load_dwordx4 v[76:79], v6, s[32:35], s63 offen offset:0 sc1
  v_mfma_f32_32x32x16_bf16 v[32:47], v[152:155], v[108:111], v[32:47]
  s_barrier
  ds_read_b64_tr_b16 v[128:129], v210 offset:0
  ds_read_b64_tr_b16 v[130:131], v210 offset:2048
  ds_read_b64_tr_b16 v[132:133], v211 offset:0
  ds_read_b64_tr_b16 v[134:135], v211 offset:2048
  ds_read_b64_tr_b16 v[136:137], v210 offset:1024
  ds_read_b64_tr_b16 v[138:139], v210 offset:3072
  ds_read_b64_tr_b16 v[140:141], v211 offset:1024
  ds_read_b64_tr_b16 v[142:143], v211 offset:3072
  ds_read_b64_tr_b16 v[144:145], v210 offset:4096
  ds_read_b64_tr_b16 v[146:147], v210 offset:6144
  ds_read_b64_tr_b16 v[148:149], v211 offset:4096
  ds_read_b64_tr_b16 v[150:151], v211 offset:6144
  s_waitcnt vmcnt(7) lgkmcnt(8)
  ds_read_b64_tr_b16 v[152:153], v210 offset:5120
  ds_read_b64_tr_b16 v[154:155], v210 offset:7168
  ds_read_b64_tr_b16 v[156:157], v211 offset:5120
  ds_read_b64_tr_b16 v[158:159], v211 offset:7168
  v_mfma_f32_32x32x16_bf16 v[48:63], v[132:135], v[112:115], v[48:63]
  buffer_load_dwordx4 v[80:83], v6, s[32:35], s63 offen offset:1024 sc1
  v_mfma_f32_32x32x16_bf16 v[32:47], v[128:131], v[112:115], v[32:47]
  s_waitcnt vmcnt(7) lgkmcnt(8)
  ds_read_b64_tr_b16 v[128:129], v210 offset:8192
  ds_read_b64_tr_b16 v[130:131], v210 offset:10240
  ds_read_b64_tr_b16 v[132:133], v211 offset:8192
  ds_read_b64_tr_b16 v[134:135], v211 offset:10240
  v_mfma_f32_32x32x16_bf16 v[48:63], v[140:143], v[116:119], v[48:63]
  buffer_load_dwordx4 v[84:87], v6, s[32:35], s63 offen offset:2048 sc1
  v_mfma_f32_32x32x16_bf16 v[32:47], v[136:139], v[116:119], v[32:47]
  s_waitcnt vmcnt(7) lgkmcnt(8)
  ds_read_b64_tr_b16 v[136:137], v210 offset:9216
  ds_read_b64_tr_b16 v[138:139], v210 offset:11264
  ds_read_b64_tr_b16 v[140:141], v211 offset:9216
  ds_read_b64_tr_b16 v[142:143], v211 offset:11264
  v_mfma_f32_32x32x16_bf16 v[48:63], v[148:151], v[120:123], v[48:63]
  buffer_load_dwordx4 v[88:91], v6, s[32:35], s63 offen offset:3072 sc1
  v_mfma_f32_32x32x16_bf16 v[32:47], v[144:147], v[120:123], v[32:47]
  s_waitcnt vmcnt(7) lgkmcnt(8)
  ds_read_b64_tr_b16 v[144:145], v216 offset:12288
  ds_read_b64_tr_b16 v[146:147], v216 offset:12800
  ds_read_b64_tr_b16 v[148:149], v217 offset:12288
  ds_read_b64_tr_b16 v[150:151], v217 offset:12800
  v_mfma_f32_32x32x16_bf16 v[48:63], v[156:159], v[124:127], v[48:63]
  s_add_u32 s63, s63, 4096
  buffer_load_dwordx4 v[92:95], v6, s[32:35], s63 offen offset:0 sc1
  v_mfma_f32_32x32x16_bf16 v[32:47], v[152:155], v[124:127], v[32:47]
  s_waitcnt vmcnt(7) lgkmcnt(8)
  ds_read_b64_tr_b16 v[152:153], v212 offset:0
  ds_read_b64_tr_b16 v[154:155], v212 offset:2048
  ds_read_b64_tr_b16 v[156:157], v213 offset:0
  ds_read_b64_tr_b16 v[158:159], v213 offset:2048
  v_mfma_f32_32x32x16_bf16 v[48:63], v[132:135], v[64:67], v[48:63]
  buffer_load_dwordx4 v[96:99], v6, s[32:35], s63 offen offset:1024 sc1
  v_mfma_f32_32x32x16_bf16 v[32:47], v[128:131], v[64:67], v[32:47]
  s_waitcnt vmcnt(7) lgkmcnt(8)
  ds_read_b64_tr_b16 v[128:129], v212 offset:1024
  ds_read_b64_tr_b16 v[130:131], v212 offset:3072
  ds_read_b64_tr_b16 v[132:133], v213 offset:1024
  ds_read_b64_tr_b16 v[134:135], v213 offset:3072
  v_mfma_f32_32x32x16_bf16 v[48:63], v[140:143], v[68:71], v[48:63]
  buffer_load_dwordx4 v[100:103], v6, s[32:35], s63 offen offset:2048 sc1
  v_mfma_f32_32x32x16_bf16 v[32:47], v[136:139], v[68:71], v[32:47]
  s_waitcnt vmcnt(7) lgkmcnt(8)
  ds_read_b64_tr_b16 v[136:137], v212 offset:4096
  ds_read_b64_tr_b16 v[138:139], v212 offset:6144
  ds_read_b64_tr_b16 v[140:141], v213 offset:4096
  ds_read_b64_tr_b16 v[142:143], v213 offset:6144
  v_mfma_f32_32x32x16_bf16 v[48:63], v[148:151], v[72:75], v[48:63]
  s_add_u32 s60, s88, 6
  s_and_b32 s60, s60, 7
  s_mul_i32 s60, s60, 7168
  s_add_u32 s63, s64, s60
  buffer_load_dwordx4 v[104:107], v6, s[32:35], s63 offen offset:0 sc1
  v_mfma_f32_32x32x16_bf16 v[32:47], v[144:147], v[72:75], v[32:47]
  s_waitcnt vmcnt(7) lgkmcnt(8)
  ds_read_b64_tr_b16 v[144:145], v212 offset:5120
  ds_read_b64_tr_b16 v[146:147], v212 offset:7168
  ds_read_b64_tr_b16 v[148:149], v213 offset:5120
  ds_read_b64_tr_b16 v[150:151], v213 offset:7168
  v_mfma_f32_32x32x16_bf16 v[48:63], v[156:159], v[76:79], v[48:63]
  buffer_load_dwordx4 v[108:111], v6, s[32:35], s63 offen offset:1024 sc1
  v_mfma_f32_32x32x16_bf16 v[32:47], v[152:155], v[76:79], v[32:47]
  s_waitcnt vmcnt(7) lgkmcnt(8)
  ds_read_b64_tr_b16 v[152:153], v212 offset:8192
  ds_read_b64_tr_b16 v[154:155], v212 offset:10240
  ds_read_b64_tr_b16 v[156:157], v213 offset:8192
  ds_read_b64_tr_b16 v[158:159], v213 offset:10240
  v_mfma_f32_32x32x16_bf16 v[48:63], v[132:135], v[80:83], v[48:63]
  buffer_load_dwordx4 v[112:115], v6, s[32:35], s63 offen offset:2048 sc1
  v_mfma_f32_32x32x16_bf16 v[32:47], v[128:131], v[80:83], v[32:47]
  s_waitcnt vmcnt(7) lgkmcnt(8)
  ds_read_b64_tr_b16 v[128:129], v212 offset:9216
  ds_read_b64_tr_b16 v[130:131], v212 offset:11264
  ds_read_b64_tr_b16 v[132:133], v213 offset:9216
  ds_read_b64_tr_b16 v[134:135], v213 offset:11264
  v_mfma_f32_32x32x16_bf16 v[48:63], v[140:143], v[84:87], v[48:63]
  buffer_load_dwordx4 v[116:119], v6, s[32:35], s63 offen offset:3072 sc1
  v_mfma_f32_32x32x16_bf16 v[32:47], v[136:139], v[84:87], v[32:47]
  s_waitcnt vmcnt(7) lgkmcnt(8)
  ds_read_b64_tr_b16 v[136:137], v218 offset:12288
  ds_read_b64_tr_b16 v[138:139], v218 offset:12800
  ds_read_b64_tr_b16 v[140:141], v219 offset:12288
  ds_read_b64_tr_b16 v[142:143], v219 offset:12800
  v_mfma_f32_32x32x16_bf16 v[48:63], v[148:151], v[88:91], v[48:63]
  s_add_u32 s63, s63, 4096
  buffer_load_dwordx4 v[120:123], v6, s[32:35], s63 offen offset:0 sc1
  v_mfma_f32_32x32x16_bf16 v[32:47], v[144:147], v[88:91], v[32:47]
  s_waitcnt vmcnt(7) lgkmcnt(8)
  v_mfma_f32_32x32x16_bf16 v[48:63], v[156:159], v[92:95], v[48:63]
  buffer_load_dwordx4 v[124:127], v6, s[32:35], s63 offen offset:1024 sc1
  v_mfma_f32_32x32x16_bf16 v[32:47], v[152:155], v[92:95], v[32:47]
  s_waitcnt vmcnt(7) lgkmcnt(4)
  v_mfma_f32_32x32x16_bf16 v[48:63], v[132:135], v[96:99], v[48:63]
  buffer_load_dwordx4 v[64:67], v6, s[32:35], s63 offen offset:2048 sc1
  v_mfma_f32_32x32x16_bf16 v[32:47], v[128:131], v[96:99], v[32:47]
  s_waitcnt vmcnt(7) lgkmcnt(0)
  v_mfma_f32_32x32x16_bf16 v[48:63], v[140:143], v[100:103], v[48:63]
  s_add_u32 s60, s88, 7
  s_and_b32 s60, s60, 7
  s_mul_i32 s60, s60, 7168
  s_add_u32 s63, s64, s60
  buffer_load_dwordx4 v[68:71], v6, s[32:35], s63 offen offset:0 sc1
  v_mfma_f32_32x32x16_bf16 v[32:47], v[136:139], v[100:103], v[32:47]
  s_barrier
  ds_read_b64_tr_b16 v[144:145], v212 offset:28672
  ds_read_b64_tr_b16 v[146:147], v212 offset:30720
  ds_read_b64_tr_b16 v[148:149], v213 offset:28672
  ds_read_b64_tr_b16 v[150:151], v213 offset:30720
  ds_read_b64_tr_b16 v[152:153], v212 offset:29696
  ds_read_b64_tr_b16 v[154:155], v212 offset:31744
  ds_read_b64_tr_b16 v[156:157], v213 offset:29696
  ds_read_b64_tr_b16 v[158:159], v213 offset:31744
  ds_read_b64_tr_b16 v[128:129], v212 offset:32768
  ds_read_b64_tr_b16 v[130:131], v212 offset:34816
  ds_read_b64_tr_b16 v[132:133], v213 offset:32768
  ds_read_b64_tr_b16 v[134:135], v213 offset:34816
  s_waitcnt vmcnt(7) lgkmcnt(8)
  ds_read_b64_tr_b16 v[136:137], v212 offset:33792
  ds_read_b64_tr_b16 v[138:139], v212 offset:35840
  ds_read_b64_tr_b16 v[140:141], v213 offset:33792
  ds_read_b64_tr_b16 v[142:143], v213 offset:35840
  v_mfma_f32_32x32x16_bf16 v[48:63], v[148:151], v[104:107], v[48:63]
  buffer_load_dwordx4 v[72:75], v6, s[32:35], s63 offen offset:1024 sc1
  v_mfma_f32_32x32x16_bf16 v[32:47], v[144:147], v[104:107], v[32:47]
  s_waitcnt vmcnt(7) lgkmcnt(8)
  ds_read_b64_tr_b16 v[144:145], v212 offset:36864
  ds_read_b64_tr_b16 v[146:147], v212 offset:38912
  ds_read_b64_tr_b16 v[148:149], v213 offset:36864
  ds_read_b64_tr_b16 v[150:151], v213 offset:38912
  v_mfma_f32_32x32x16_bf16 v[48:63], v[156:159], v[108:111], v[48:63]
  buffer_load_dwordx4 v[76:79], v6, s[32:35], s63 offen offset:2048 sc1
  v_mfma_f32_32x32x16_bf16 v[32:47], v[152:155], v[108:111], v[32:47]
  s_waitcnt vmcnt(7) lgkmcnt(8)
  ds_read_b64_tr_b16 v[152:153], v212 offset:37888
  ds_read_b64_tr_b16 v[154:155], v212 offset:39936
  ds_read_b64_tr_b16 v[156:157], v213 offset:37888
  ds_read_b64_tr_b16 v[158:159], v213 offset:39936
  v_mfma_f32_32x32x16_bf16 v[48:63], v[132:135], v[112:115], v[48:63]
  buffer_load_dwordx4 v[80:83], v6, s[32:35], s63 offen offset:3072 sc1
  v_mfma_f32_32x32x16_bf16 v[32:47], v[128:131], v[112:115], v[32:47]
  s_waitcnt vmcnt(7) lgkmcnt(8)
  ds_read_b64_tr_b16 v[128:129], v218 offset:40960
  ds_read_b64_tr_b16 v[130:131], v218 offset:41472
  ds_read_b64_tr_b16 v[132:133], v219 offset:40960
  ds_read_b64_tr_b16 v[134:135], v219 offset:41472
  v_mfma_f32_32x32x16_bf16 v[48:63], v[140:143], v[116:119], v[48:63]
  s_add_u32 s63, s63, 4096
  buffer_load_dwordx4 v[84:87], v6, s[32:35], s63 offen offset:0 sc1
  v_mfma_f32_32x32x16_bf16 v[32:47], v[136:139], v[116:119], v[32:47]
  s_waitcnt vmcnt(7) lgkmcnt(8)
  ds_read_b64_tr_b16 v[136:137], v208 offset:0
  ds_read_b64_tr_b16 v[138:139], v208 offset:2048
  ds_read_b64_tr_b16 v[140:141], v209 offset:0
  ds_read_b64_tr_b16 v[142:143], v209 offset:2048
  v_mfma_f32_32x32x16_bf16 v[48:63], v[148:151], v[120:123], v[48:63]
  buffer_load_dwordx4 v[88:91], v6, s[32:35], s63 offen offset:1024 sc1
  v_mfma_f32_32x32x16_bf16 v[32:47], v[144:147], v[120:123], v[32:47]
  s_waitcnt vmcnt(7) lgkmcnt(8)
  ds_read_b64_tr_b16 v[144:145], v208 offset:1024
  ds_read_b64_tr_b16 v[146:147], v208 offset:3072
  ds_read_b64_tr_b16 v[148:149], v209 offset:1024
  ds_read_b64_tr_b16 v[150:151], v209 offset:3072
  v_mfma_f32_32x32x16_bf16 v[48:63], v[156:159], v[124:127], v[48:63]
  buffer_load_dwordx4 v[92:95], v6, s[32:35], s63 offen offset:2048 sc1
  v_mfma_f32_32x32x16_bf16 v[32:47], v[152:155], v[124:127], v[32:47]
  s_waitcnt vmcnt(7) lgkmcnt(8)
  ds_read_b64_tr_b16 v[152:153], v208 offset:4096
  ds_read_b64_tr_b16 v[154:155], v208 offset:6144
  ds_read_b64_tr_b16 v[156:157], v209 offset:4096
  ds_read_b64_tr_b16 v[158:159], v209 offset:6144
  v_mfma_f32_32x32x16_bf16 v[48:63], v[132:135], v[64:67], v[48:63]
  v_mfma_f32_32x32x16_bf16 v[32:47], v[128:131], v[64:67], v[32:47]
  s_waitcnt vmcnt(6) lgkmcnt(8)
  ds_read_b64_tr_b16 v[128:129], v208 offset:5120
  ds_read_b64_tr_b16 v[130:131], v208 offset:7168
  ds_read_b64_tr_b16 v[132:133], v209 offset:5120
  ds_read_b64_tr_b16 v[134:135], v209 offset:7168
  v_mfma_f32_32x32x16_bf16 v[48:63], v[140:143], v[68:71], v[48:63]
  v_mfma_f32_32x32x16_bf16 v[32:47], v[136:139], v[68:71], v[32:47]
  s_waitcnt vmcnt(5) lgkmcnt(8)
  ds_read_b64_tr_b16 v[136:137], v208 offset:8192
  ds_read_b64_tr_b16 v[138:139], v208 offset:10240
  ds_read_b64_tr_b16 v[140:141], v209 offset:8192
  ds_read_b64_tr_b16 v[142:143], v209 offset:10240
  v_mfma_f32_32x32x16_bf16 v[48:63], v[148:151], v[72:75], v[48:63]
  v_mfma_f32_32x32x16_bf16 v[32:47], v[144:147], v[72:75], v[32:47]
  s_waitcnt vmcnt(4) lgkmcnt(8)
  ds_read_b64_tr_b16 v[144:145], v208 offset:9216
  ds_read_b64_tr_b16 v[146:147], v208 offset:11264
  ds_read_b64_tr_b16 v[148:149], v209 offset:9216
  ds_read_b64_tr_b16 v[150:151], v209 offset:11264
  v_mfma_f32_32x32x16_bf16 v[48:63], v[156:159], v[76:79], v[48:63]
  v_mfma_f32_32x32x16_bf16 v[32:47], v[152:155], v[76:79], v[32:47]
  s_waitcnt vmcnt(3) lgkmcnt(8)
  ds_read_b64_tr_b16 v[152:153], v214 offset:12288
  ds_read_b64_tr_b16 v[154:155], v214 offset:12800
  ds_read_b64_tr_b16 v[156:157], v215 offset:12288
  ds_read_b64_tr_b16 v[158:159], v215 offset:12800
  v_mfma_f32_32x32x16_bf16 v[48:63], v[132:135], v[80:83], v[48:63]
  v_mfma_f32_32x32x16_bf16 v[32:47], v[128:131], v[80:83], v[32:47]
  s_waitcnt vmcnt(2) lgkmcnt(8)
  v_mfma_f32_32x32x16_bf16 v[48:63], v[140:143], v[84:87], v[48:63]
  v_mfma_f32_32x32x16_bf16 v[32:47], v[136:139], v[84:87], v[32:47]
  s_waitcnt vmcnt(1) lgkmcnt(4)
  v_mfma_f32_32x32x16_bf16 v[48:63], v[148:151], v[88:91], v[48:63]
  v_mfma_f32_32x32x16_bf16 v[32:47], v[144:147], v[88:91], v[32:47]
  s_waitcnt vmcnt(0) lgkmcnt(0)
  v_mfma_f32_32x32x16_bf16 v[48:63], v[156:159], v[92:95], v[48:63]
  v_mfma_f32_32x32x16_bf16 v[32:47], v[152:155], v[92:95], v[32:47]
  s_nop 7
  s_nop 2
  ds_write_b128 v162, v[48:51] offset:0
  ds_write_b128 v162, v[52:55] offset:1024
  ds_write_b128 v162, v[56:59] offset:2048
  ds_write_b128 v162, v[60:63] offset:3072
  s_waitcnt lgkmcnt(0)
  s_barrier
  ds_read_b128 v[48:51], v163 offset:0
  ds_read_b128 v[52:55], v163 offset:1024
  ds_read_b128 v[56:59], v163 offset:2048
  ds_read_b128 v[60:63], v163 offset:3072
  s_waitcnt lgkmcnt(3)
  v_pk_add_f32 v[32:33], v[32:33], v[48:49]
  v_pk_add_f32 v[34:35], v[34:35], v[50:51]
  v_cvt_pk_bf16_f32 v48, v32, v33
  v_cvt_pk_bf16_f32 v50, v34, v35
  v_lshlrev_b32 v32, 16, v48
  v_and_b32 v33, 0xffff0000, v48
  v_lshlrev_b32 v34, 16, v50
  v_and_b32 v35, 0xffff0000, v50
  v_pk_add_f32 v[32:33], v[32:33], v[168:169]
  v_pk_add_f32 v[34:35], v[34:35], v[170:171]
  v_cvt_pk_bf16_f32 v64, v32, v33
  v_cvt_pk_bf16_f32 v65, v34, v35
  s_waitcnt lgkmcnt(2)
  v_pk_add_f32 v[36:37], v[36:37], v[52:53]
  v_pk_add_f32 v[38:39], v[38:39], v[54:55]
  v_cvt_pk_bf16_f32 v52, v36, v37
  v_cvt_pk_bf16_f32 v54, v38, v39
  v_lshlrev_b32 v36, 16, v52
  v_and_b32 v37, 0xffff0000, v52
  v_lshlrev_b32 v38, 16, v54
  v_and_b32 v39, 0xffff0000, v54
  v_pk_add_f32 v[36:37], v[36:37], v[172:173]
  v_pk_add_f32 v[38:39], v[38:39], v[174:175]
  v_cvt_pk_bf16_f32 v66, v36, v37
  v_cvt_pk_bf16_f32 v67, v38, v39
  s_waitcnt lgkmcnt(1)
  v_pk_add_f32 v[40:41], v[40:41], v[56:57]
  v_pk_add_f32 v[42:43], v[42:43], v[58:59]
  v_cvt_pk_bf16_f32 v56, v40, v41
  v_cvt_pk_bf16_f32 v58, v42, v43
  v_lshlrev_b32 v40, 16, v56
  v_and_b32 v41, 0xffff0000, v56
  v_lshlrev_b32 v42, 16, v58
  v_and_b32 v43, 0xffff0000, v58
  v_pk_add_f32 v[40:41], v[40:41], v[176:177]
  v_pk_add_f32 v[42:43], v[42:43], v[178:179]
  v_cvt_pk_bf16_f32 v68, v40, v41
  v_cvt_pk_bf16_f32 v69, v42, v43
  s_waitcnt lgkmcnt(0)
  v_pk_add_f32 v[44:45], v[44:45], v[60:61]
  v_pk_add_f32 v[46:47], v[46:47], v[62:63]
  v_cvt_pk_bf16_f32 v60, v44, v45
  v_cvt_pk_bf16_f32 v62, v46, v47
  v_lshlrev_b32 v44, 16, v60
  v_and_b32 v45, 0xffff0000, v60
  v_lshlrev_b32 v46, 16, v62
  v_and_b32 v47, 0xffff0000, v62
  v_pk_add_f32 v[44:45], v[44:45], v[180:181]
  v_pk_add_f32 v[46:47], v[46:47], v[182:183]
  v_cvt_pk_bf16_f32 v70, v44, v45
  v_cvt_pk_bf16_f32 v71, v46, v47
  v_permlane32_swap_b32 v64, v66
  v_permlane32_swap_b32 v65, v67
  v_permlane32_swap_b32 v68, v70
  v_permlane32_swap_b32 v69, v71
  ds_write_b128 v184, v[64:67] offset:0
  ds_write_b128 v184, v[68:71] offset:32
  s_waitcnt lgkmcnt(0)
  s_barrier
  ds_read_b128 v[72:75], v185 offset:0
  ds_read_b128 v[76:79], v185 offset:1152
  s_waitcnt lgkmcnt(1)
  buffer_store_dwordx4 v[72:75], v186, s[24:27], s74 offen nt
  s_waitcnt lgkmcnt(0)
  buffer_store_dwordx4 v[76:79], v186, s[24:27], s75 offen nt
  s_endpgm
  s_nop 0
Lhelper2:
  s_barrier
  s_add_u32 s60, s45, 0
  s_mul_i32 s61, s60, 114688
  s_mul_i32 s62, s45, 7168
  s_add_u32 m0, s62, 0
  s_nop 0
  buffer_load_dwordx4 v241, s[16:19], s61 offen lds
  s_add_u32 m0, s62, 1024
  s_nop 0
  buffer_load_dwordx4 v242, s[16:19], s61 offen lds
  s_add_u32 m0, s62, 2048
  s_nop 0
  buffer_load_dwordx4 v243, s[16:19], s61 offen lds
  s_add_u32 m0, s62, 3072
  s_nop 0
  buffer_load_dwordx4 v244, s[16:19], s61 offen lds
  s_add_u32 m0, s62, 4096
  s_nop 0
  buffer_load_dwordx4 v245, s[16:19], s61 offen lds
  s_add_u32 m0, s62, 5120
  s_nop 0
  buffer_load_dwordx4 v246, s[16:19], s61 offen lds
  s_add_u32 m0, s62, 6144
  s_nop 0
  buffer_load_dwordx4 v247, s[16:19], s61 offen lds
  s_add_u32 s60, s45, 4
  s_mul_i32 s61, s60, 114688
  s_mul_i32 s62, s45, 7168
  s_add_u32 m0, s62, 28672
  s_nop 0
  buffer_load_dwordx4 v241, s[16:19], s61 offen lds
  s_add_u32 m0, s62, 29696
  s_nop 0
  buffer_load_dwordx4 v242, s[16:19], s61 offen lds
  s_add_u32 m0, s62, 30720
  s_nop 0
  buffer_load_dwordx4 v243, s[16:19], s61 offen lds
  s_add_u32 m0, s62, 31744
  s_nop 0
  buffer_load_dwordx4 v244, s[16:19], s61 offen lds
  s_add_u32 m0, s62, 32768
  s_nop 0
  buffer_load_dwordx4 v245, s[16:19], s61 offen lds
  s_add_u32 m0, s62, 33792
  s_nop 0
  buffer_load_dwordx4 v246, s[16:19], s61 offen lds
  s_add_u32 m0, s62, 34816
  s_nop 0
  buffer_load_dwordx4 v247, s[16:19], s61 offen lds
  s_cmp_ge_u32 s45, 2
  s_cbranch_scc1 Lnour_26
  s_add_u32 s60, s45, 12
  s_mul_i32 s61, s60, 114688
  buffer_load_dwordx4 v[156:159], v241, s[16:19], s61 offen
  buffer_load_dwordx4 v[160:163], v242, s[16:19], s61 offen
  buffer_load_dwordx4 v[164:167], v243, s[16:19], s61 offen
  buffer_load_dwordx4 v[168:171], v244, s[16:19], s61 offen
  buffer_load_dwordx4 v[172:175], v245, s[16:19], s61 offen
  buffer_load_dwordx4 v[176:179], v246, s[16:19], s61 offen
  buffer_load_dwordx4 v[180:183], v247, s[16:19], s61 offen
Lnour_26:
  v_lshrrev_b32 v18, 1, v5
  v_lshlrev_b32 v18, 4, v18
  v_and_b32 v19, 1, v5
  v_lshl_add_u32 v18, v19, 2, v18
  v_lshrrev_b32 v19, 2, v4
  v_add_u32 v18, v18, v19
  v_mul_u32_u24 v18, 224, v18
  v_and_b32 v19, 3, v1
  v_lshl_add_u32 v68, v19, 3, v18
  s_mul_i32 s60, s45, 7168
  v_add_u32 v68, s60, v68
  v_add_u32 v69, 144384, v68
  v_mov_b32 v70, 0x3f803f80
  v_mov_b32 v32, 0
  v_mov_b32 v33, 0
  v_mov_b32 v34, 0
  v_mov_b32 v35, 0
  v_mov_b32 v36, 0
  v_mov_b32 v37, 0
  v_mov_b32 v38, 0
  ds_read_b64_tr_b16 v[40:41], v68 offset:57344
  ds_read_b64_tr_b16 v[42:43], v68 offset:59136
  ds_read_b64_tr_b16 v[44:45], v68 offset:57376
  ds_read_b64_tr_b16 v[46:47], v68 offset:59168
  ds_read_b64_tr_b16 v[48:49], v68 offset:57408
  ds_read_b64_tr_b16 v[50:51], v68 offset:59200
  ds_read_b64_tr_b16 v[52:53], v68 offset:57440
  ds_read_b64_tr_b16 v[54:55], v68 offset:59232
  ds_read_b64_tr_b16 v[56:57], v68 offset:57472
  ds_read_b64_tr_b16 v[58:59], v68 offset:59264
  ds_read_b64_tr_b16 v[60:61], v68 offset:57504
  ds_read_b64_tr_b16 v[62:63], v68 offset:59296
  ds_read_b64_tr_b16 v[64:65], v68 offset:57536
  ds_read_b64_tr_b16 v[66:67], v68 offset:59328
  s_waitcnt lgkmcnt(0)
  v_dot2c_f32_bf16 v32, v40, v70
  v_dot2c_f32_bf16 v33, v44, v70
  v_dot2c_f32_bf16 v34, v48, v70
  v_dot2c_f32_bf16 v35, v52, v70
  v_dot2c_f32_bf16 v36, v56, v70
  v_dot2c_f32_bf16 v37, v60, v70
  v_dot2c_f32_bf16 v38, v64, v70
  v_dot2c_f32_bf16 v32, v41, v70
  v_dot2c_f32_bf16 v33, v45, v70
  v_dot2c_f32_bf16 v34, v49, v70
  v_dot2c_f32_bf16 v35, v53, v70
  v_dot2c_f32_bf16 v36, v57, v70
  v_dot2c_f32_bf16 v37, v61, v70
  v_dot2c_f32_bf16 v38, v65, v70
  v_dot2c_f32_bf16 v32, v42, v70
  v_dot2c_f32_bf16 v33, v46, v70
  v_dot2c_f32_bf16 v34, v50, v70
  v_dot2c_f32_bf16 v35, v54, v70
  v_dot2c_f32_bf16 v36, v58, v70
  v_dot2c_f32_bf16 v37, v62, v70
  v_dot2c_f32_bf16 v38, v66, v70
  v_dot2c_f32_bf16 v32, v43, v70
  v_dot2c_f32_bf16 v33, v47, v70
  v_dot2c_f32_bf16 v34, v51, v70
  v_dot2c_f32_bf16 v35, v55, v70
  v_dot2c_f32_bf16 v36, v59, v70
  v_dot2c_f32_bf16 v37, v63, v70
  v_dot2c_f32_bf16 v38, v67, v70
  s_barrier
  s_waitcnt vmcnt(0)
  ds_read_b64_tr_b16 v[40:41], v68 offset:0
  ds_read_b64_tr_b16 v[42:43], v68 offset:1792
  ds_read_b64_tr_b16 v[44:45], v68 offset:32
  ds_read_b64_tr_b16 v[46:47], v68 offset:1824
  ds_read_b64_tr_b16 v[48:49], v68 offset:64
  ds_read_b64_tr_b16 v[50:51], v68 offset:1856
  ds_read_b64_tr_b16 v[52:53], v68 offset:96
  ds_read_b64_tr_b16 v[54:55], v68 offset:1888
  ds_read_b64_tr_b16 v[56:57], v68 offset:128
  ds_read_b64_tr_b16 v[58:59], v68 offset:1920
  ds_read_b64_tr_b16 v[60:61], v68 offset:160
  ds_read_b64_tr_b16 v[62:63], v68 offset:1952
  ds_read_b64_tr_b16 v[64:65], v68 offset:192
  ds_read_b64_tr_b16 v[66:67], v68 offset:1984
  s_waitcnt lgkmcnt(0)
  v_dot2c_f32_bf16 v32, v40, v70
  v_dot2c_f32_bf16 v33, v44, v70
  v_dot2c_f32_bf16 v34, v48, v70
  v_dot2c_f32_bf16 v35, v52, v70
  v_dot2c_f32_bf16 v36, v56, v70
  v_dot2c_f32_bf16 v37, v60, v70
  v_dot2c_f32_bf16 v38, v64, v70
  v_dot2c_f32_bf16 v32, v41, v70
  v_dot2c_f32_bf16 v33, v45, v70
  v_dot2c_f32_bf16 v34, v49, v70
  v_dot2c_f32_bf16 v35, v53, v70
  v_dot2c_f32_bf16 v36, v57, v70
  v_dot2c_f32_bf16 v37, v61, v70
  v_dot2c_f32_bf16 v38, v65, v70
  v_dot2c_f32_bf16 v32, v42, v70
  v_dot2c_f32_bf16 v33, v46, v70
  v_dot2c_f32_bf16 v34, v50, v70
  v_dot2c_f32_bf16 v35, v54, v70
  v_dot2c_f32_bf16 v36, v58, v70
  v_dot2c_f32_bf16 v37, v62, v70
  v_dot2c_f32_bf16 v38, v66, v70
  v_dot2c_f32_bf16 v32, v43, v70
  v_dot2c_f32_bf16 v33, v47, v70
  v_dot2c_f32_bf16 v34, v51, v70
  v_dot2c_f32_bf16 v35, v55, v70
  v_dot2c_f32_bf16 v36, v59, v70
  v_dot2c_f32_bf16 v37, v63, v70
  v_dot2c_f32_bf16 v38, v67, v70
  ds_read_b64_tr_b16 v[40:41], v68 offset:28672
  ds_read_b64_tr_b16 v[42:43], v68 offset:30464
  ds_read_b64_tr_b16 v[44:45], v68 offset:28704
  ds_read_b64_tr_b16 v[46:47], v68 offset:30496
  ds_read_b64_tr_b16 v[48:49], v68 offset:28736
  ds_read_b64_tr_b16 v[50:51], v68 offset:30528
  ds_read_b64_tr_b16 v[52:53], v68 offset:28768
  ds_read_b64_tr_b16 v[54:55], v68 offset:30560
  ds_read_b64_tr_b16 v[56:57], v68 offset:28800
  ds_read_b64_tr_b16 v[58:59], v68 offset:30592
  ds_read_b64_tr_b16 v[60:61], v68 offset:28832
  ds_read_b64_tr_b16 v[62:63], v68 offset:30624
  ds_read_b64_tr_b16 v[64:65], v68 offset:28864
  ds_read_b64_tr_b16 v[66:67], v68 offset:30656
  s_waitcnt lgkmcnt(0)
  v_dot2c_f32_bf16 v32, v40, v70
  v_dot2c_f32_bf16 v33, v44, v70
  v_dot2c_f32_bf16 v34, v48, v70
  v_dot2c_f32_bf16 v35, v52, v70
  v_dot2c_f32_bf16 v36, v56, v70
  v_dot2c_f32_bf16 v37, v60, v70
  v_dot2c_f32_bf16 v38, v64, v70
  v_dot2c_f32_bf16 v32, v41, v70
  v_dot2c_f32_bf16 v33, v45, v70
  v_dot2c_f32_bf16 v34, v49, v70
  v_dot2c_f32_bf16 v35, v53, v70
  v_dot2c_f32_bf16 v36, v57, v70
  v_dot2c_f32_bf16 v37, v61, v70
  v_dot2c_f32_bf16 v38, v65, v70
  v_dot2c_f32_bf16 v32, v42, v70
  v_dot2c_f32_bf16 v33, v46, v70
  v_dot2c_f32_bf16 v34, v50, v70
  v_dot2c_f32_bf16 v35, v54, v70
  v_dot2c_f32_bf16 v36, v58, v70
  v_dot2c_f32_bf16 v37, v62, v70
  v_dot2c_f32_bf16 v38, v66, v70
  v_dot2c_f32_bf16 v32, v43, v70
  v_dot2c_f32_bf16 v33, v47, v70
  v_dot2c_f32_bf16 v34, v51, v70
  v_dot2c_f32_bf16 v35, v55, v70
  v_dot2c_f32_bf16 v36, v59, v70
  v_dot2c_f32_bf16 v37, v63, v70
  v_dot2c_f32_bf16 v38, v67, v70
  s_barrier
  s_cmp_ge_u32 s45, 2
  s_nop 0
  s_cbranch_scc1 Lnou_27
  s_mul_i32 s60, s45, 7168
  s_add_u32 s60, s60, 144384
  v_add_u32 v18, s60, v6
  ds_write_b128 v18, v[156:159] offset:0
  ds_write_b128 v18, v[160:163] offset:1024
  ds_write_b128 v18, v[164:167] offset:2048
  ds_write_b128 v18, v[168:171] offset:3072
  ds_write_b128 v18, v[172:175] offset:4096
  ds_write_b128 v18, v[176:179] offset:5120
  ds_write_b128 v18, v[180:183] offset:6144
  ds_read_b64_tr_b16 v[40:41], v69 offset:0
  ds_read_b64_tr_b16 v[42:43], v69 offset:1792
  ds_read_b64_tr_b16 v[44:45], v69 offset:32
  ds_read_b64_tr_b16 v[46:47], v69 offset:1824
  ds_read_b64_tr_b16 v[48:49], v69 offset:64
  ds_read_b64_tr_b16 v[50:51], v69 offset:1856
  ds_read_b64_tr_b16 v[52:53], v69 offset:96
  ds_read_b64_tr_b16 v[54:55], v69 offset:1888
  ds_read_b64_tr_b16 v[56:57], v69 offset:128
  ds_read_b64_tr_b16 v[58:59], v69 offset:1920
  ds_read_b64_tr_b16 v[60:61], v69 offset:160
  ds_read_b64_tr_b16 v[62:63], v69 offset:1952
  ds_read_b64_tr_b16 v[64:65], v69 offset:192
  ds_read_b64_tr_b16 v[66:67], v69 offset:1984
  s_waitcnt lgkmcnt(0)
  v_dot2c_f32_bf16 v32, v40, v70
  v_dot2c_f32_bf16 v33, v44, v70
  v_dot2c_f32_bf16 v34, v48, v70
  v_dot2c_f32_bf16 v35, v52, v70
  v_dot2c_f32_bf16 v36, v56, v70
  v_dot2c_f32_bf16 v37, v60, v70
  v_dot2c_f32_bf16 v38, v64, v70
  v_dot2c_f32_bf16 v32, v41, v70
  v_dot2c_f32_bf16 v33, v45, v70
  v_dot2c_f32_bf16 v34, v49, v70
  v_dot2c_f32_bf16 v35, v53, v70
  v_dot2c_f32_bf16 v36, v57, v70
  v_dot2c_f32_bf16 v37, v61, v70
  v_dot2c_f32_bf16 v38, v65, v70
  v_dot2c_f32_bf16 v32, v42, v70
  v_dot2c_f32_bf16 v33, v46, v70
  v_dot2c_f32_bf16 v34, v50, v70
  v_dot2c_f32_bf16 v35, v54, v70
  v_dot2c_f32_bf16 v36, v58, v70
  v_dot2c_f32_bf16 v37, v62, v70
  v_dot2c_f32_bf16 v38, v66, v70
  v_dot2c_f32_bf16 v32, v43, v70
  v_dot2c_f32_bf16 v33, v47, v70
  v_dot2c_f32_bf16 v34, v51, v70
  v_dot2c_f32_bf16 v35, v55, v70
  v_dot2c_f32_bf16 v36, v59, v70
  v_dot2c_f32_bf16 v37, v63, v70
  v_dot2c_f32_bf16 v38, v67, v70
  s_nop 2
Lnou_27:
  s_cmp_ge_u32 s37, 14
  s_cbranch_scc1 Lnocq_28
  s_add_u32 s60, s88, s48
  s_add_u32 s60, s60, 2
  s_and_b32 s60, s60, 7
  s_lshl_b32 s65, s49, 3
  s_add_u32 s60, s60, s65
  s_mul_i32 s63, s60, 100352
  buffer_load_dwordx4 v[72:75], v240, s[20:23], s63 offen
  s_add_u32 s63, s63, 7168
  buffer_load_dwordx4 v[76:79], v240, s[20:23], s63 offen
  s_add_u32 s63, s63, 7168
  buffer_load_dwordx4 v[80:83], v240, s[20:23], s63 offen
  s_add_u32 s63, s63, 7168
  buffer_load_dwordx4 v[84:87], v240, s[20:23], s63 offen
  s_add_u32 s63, s63, 7168
  buffer_load_dwordx4 v[88:91], v240, s[20:23], s63 offen
  s_add_u32 s63, s63, 7168
  buffer_load_dwordx4 v[92:95], v240, s[20:23], s63 offen
  s_add_u32 s63, s63, 7168
  buffer_load_dwordx4 v[96:99], v240, s[20:23], s63 offen
  s_add_u32 s63, s63, 7168
  buffer_load_dwordx4 v[100:103], v240, s[20:23], s63 offen
  s_add_u32 s63, s63, 7168
  buffer_load_dwordx4 v[104:107], v240, s[20:23], s63 offen
  s_add_u32 s63, s63, 7168
  buffer_load_dwordx4 v[108:111], v240, s[20:23], s63 offen
  s_add_u32 s63, s63, 7168
  buffer_load_dwordx4 v[112:115], v240, s[20:23], s63 offen
  s_add_u32 s63, s63, 7168
  buffer_load_dwordx4 v[116:119], v240, s[20:23], s63 offen
  s_add_u32 s63, s63, 7168
  buffer_load_dwordx4 v[120:123], v240, s[20:23], s63 offen
  s_add_u32 s63, s63, 7168
  buffer_load_dwordx4 v[124:127], v240, s[20:23], s63 offen
Lnocq_28:
  v_mov_b32 v18, v32
  s_nop 1
  v_permlane32_swap_b32 v32, v18
  v_add_f32 v32, v32, v18
  v_mov_b32 v18, v32
  s_nop 1
  v_permlane16_swap_b32 v32, v18
  v_add_f32 v32, v32, v18
  v_mov_b32 v18, v33
  s_nop 1
  v_permlane32_swap_b32 v33, v18
  v_add_f32 v33, v33, v18
  v_mov_b32 v18, v33
  s_nop 1
  v_permlane16_swap_b32 v33, v18
  v_add_f32 v33, v33, v18
  v_mov_b32 v18, v34
  s_nop 1
  v_permlane32_swap_b32 v34, v18
  v_add_f32 v34, v34, v18
  v_mov_b32 v18, v34
  s_nop 1
  v_permlane16_swap_b32 v34, v18
  v_add_f32 v34, v34, v18
  v_mov_b32 v18, v35
  s_nop 1
  v_permlane32_swap_b32 v35, v18
  v_add_f32 v35, v35, v18
  v_mov_b32 v18, v35
  s_nop 1
  v_permlane16_swap_b32 v35, v18
  v_add_f32 v35, v35, v18
  v_mov_b32 v18, v36
  s_nop 1
  v_permlane32_swap_b32 v36, v18
  v_add_f32 v36, v36, v18
  v_mov_b32 v18, v36
  s_nop 1
  v_permlane16_swap_b32 v36, v18
  v_add_f32 v36, v36, v18
  v_mov_b32 v18, v37
  s_nop 1
  v_permlane32_swap_b32 v37, v18
  v_add_f32 v37, v37, v18
  v_mov_b32 v18, v37
  s_nop 1
  v_permlane16_swap_b32 v37, v18
  v_add_f32 v37, v37, v18
  v_mov_b32 v18, v38
  s_nop 1
  v_permlane32_swap_b32 v38, v18
  v_add_f32 v38, v38, v18
  v_mov_b32 v18, v38
  s_nop 1
  v_permlane16_swap_b32 v38, v18
  v_add_f32 v38, v38, v18
  s_mul_i32 s60, s45, 448
  s_add_u32 s60, s60, 158720
  v_lshl_add_u32 v18, v4, 2, s60
  ds_write_b32 v18, v32 offset:0
  ds_write_b32 v18, v33 offset:64
  ds_write_b32 v18, v34 offset:128
  ds_write_b32 v18, v35 offset:192
  ds_write_b32 v18, v36 offset:256
  ds_write_b32 v18, v37 offset:320
  ds_write_b32 v18, v38 offset:384
  s_waitcnt lgkmcnt(0)
  s_barrier
  s_cmp_lg_u32 s38, 4
  s_cbranch_scc1 Lnocs1_29
  v_min_u32 v18, 55, v1
  v_lshlrev_b32 v18, 3, v18
  v_add_u32 v19, 158720, v18
  ds_read_b64 v[40:41], v19 offset:0
  ds_read_b64 v[42:43], v19 offset:448
  ds_read_b64 v[44:45], v19 offset:896
  ds_read_b64 v[46:47], v19 offset:1344
  s_waitcnt lgkmcnt(0)
  v_add_f32 v40, v40, v42
  v_add_f32 v44, v44, v46
  v_add_f32 v40, v40, v44
  v_add_f32 v41, v41, v43
  v_add_f32 v45, v45, v47
  v_add_f32 v41, v41, v45
  v_add_u32 v19, 162240, v18
  ds_write_b64 v19, v[40:41]
  s_waitcnt lgkmcnt(0)
  s_nop 0
Lnocs1_29:
  s_barrier
  s_cmp_ge_u32 s37, 14
  s_cbranch_scc1 Lend
  s_add_u32 s60, s88, s48
  s_and_b32 s60, s60, 7
  s_lshl_b32 s65, s49, 3
  s_add_u32 s60, s60, s65
  s_mul_i32 s63, s60, 100352
  s_mul_i32 s61, s45, 14336
  s_add_u32 m0, s61, 86016
  s_nop 0
  buffer_load_dwordx4 v240, s[20:23], s63 offen lds
  s_add_u32 s63, s63, 7168
  s_add_u32 m0, s61, 87040
  s_nop 0
  buffer_load_dwordx4 v240, s[20:23], s63 offen lds
  s_add_u32 s63, s63, 7168
  s_add_u32 m0, s61, 88064
  s_nop 0
  buffer_load_dwordx4 v240, s[20:23], s63 offen lds
  s_add_u32 s63, s63, 7168
  s_add_u32 m0, s61, 89088
  s_nop 0
  buffer_load_dwordx4 v240, s[20:23], s63 offen lds
  s_add_u32 s63, s63, 7168
  s_add_u32 m0, s61, 90112
  s_nop 0
  buffer_load_dwordx4 v240, s[20:23], s63 offen lds
  s_add_u32 s63, s63, 7168
  s_add_u32 m0, s61, 91136
  s_nop 0
  buffer_load_dwordx4 v240, s[20:23], s63 offen lds
  s_add_u32 s63, s63, 7168
  s_add_u32 m0, s61, 92160
  s_nop 0
  buffer_load_dwordx4 v240, s[20:23], s63 offen lds
  s_add_u32 s63, s63, 7168
  s_add_u32 m0, s61, 93184
  s_nop 0
  buffer_load_dwordx4 v240, s[20:23], s63 offen lds
  s_add_u32 s63, s63, 7168
  s_add_u32 m0, s61, 94208
  s_nop 0
  buffer_load_dwordx4 v240, s[20:23], s63 offen lds
  s_add_u32 s63, s63, 7168
  s_add_u32 m0, s61, 95232
  s_nop 0
  buffer_load_dwordx4 v240, s[20:23], s63 offen lds
  s_add_u32 s63, s63, 7168
  s_add_u32 m0, s61, 96256
  s_nop 0
  buffer_load_dwordx4 v240, s[20:23], s63 offen lds
  s_add_u32 s63, s63, 7168
  s_add_u32 m0, s61, 97280
  s_nop 0
  buffer_load_dwordx4 v240, s[20:23], s63 offen lds
  s_add_u32 s63, s63, 7168
  s_add_u32 m0, s61, 98304
  s_nop 0
  buffer_load_dwordx4 v240, s[20:23], s63 offen lds
  s_add_u32 s63, s63, 7168
  s_add_u32 m0, s61, 99328
  s_nop 0
  buffer_load_dwordx4 v240, s[20:23], s63 offen lds
  s_add_u32 s60, s88, 4
  s_and_b32 s60, s60, 7
  s_lshl_b32 s65, s49, 3
  s_add_u32 s60, s60, s65
  s_mul_i32 s63, s60, 100352
  s_mul_i32 s65, s48, 50176
  s_add_u32 s63, s63, s65
  buffer_load_dwordx4 v[128:131], v240, s[20:23], s63 offen
  s_add_u32 s63, s63, 7168
  buffer_load_dwordx4 v[132:135], v240, s[20:23], s63 offen
  s_add_u32 s63, s63, 7168
  buffer_load_dwordx4 v[136:139], v240, s[20:23], s63 offen
  s_add_u32 s63, s63, 7168
  buffer_load_dwordx4 v[140:143], v240, s[20:23], s63 offen
  s_add_u32 s63, s63, 7168
  buffer_load_dwordx4 v[144:147], v240, s[20:23], s63 offen
  s_add_u32 s63, s63, 7168
  buffer_load_dwordx4 v[148:151], v240, s[20:23], s63 offen
  s_add_u32 s63, s63, 7168
  buffer_load_dwordx4 v[152:155], v240, s[20:23], s63 offen
  s_add_u32 s60, s88, s48
  s_add_u32 s60, s60, 5
  s_and_b32 s60, s60, 7
  s_lshl_b32 s65, s49, 3
  s_add_u32 s60, s60, s65
  s_mul_i32 s63, s60, 100352
  buffer_load_dwordx4 v[156:159], v240, s[20:23], s63 offen
  s_add_u32 s63, s63, 7168
  buffer_load_dwordx4 v[160:163], v240, s[20:23], s63 offen
  s_add_u32 s63, s63, 7168
  buffer_load_dwordx4 v[164:167], v240, s[20:23], s63 offen
  s_add_u32 s63, s63, 7168
  buffer_load_dwordx4 v[168:171], v240, s[20:23], s63 offen
  s_add_u32 s63, s63, 7168
  buffer_load_dwordx4 v[172:175], v240, s[20:23], s63 offen
  s_add_u32 s63, s63, 7168
  buffer_load_dwordx4 v[176:179], v240, s[20:23], s63 offen
  s_add_u32 s63, s63, 7168
  buffer_load_dwordx4 v[180:183], v240, s[20:23], s63 offen
  s_add_u32 s63, s63, 7168
  buffer_load_dwordx4 v[184:187], v240, s[20:23], s63 offen
  s_add_u32 s63, s63, 7168
  buffer_load_dwordx4 v[188:191], v240, s[20:23], s63 offen
  s_add_u32 s63, s63, 7168
  buffer_load_dwordx4 v[192:195], v240, s[20:23], s63 offen
  s_add_u32 s63, s63, 7168
  buffer_load_dwordx4 v[196:199], v240, s[20:23], s63 offen
  s_add_u32 s63, s63, 7168
  buffer_load_dwordx4 v[200:203], v240, s[20:23], s63 offen
  s_add_u32 s63, s63, 7168
  buffer_load_dwordx4 v[204:207], v240, s[20:23], s63 offen
  s_add_u32 s63, s63, 7168
  buffer_load_dwordx4 v[208:211], v240, s[20:23], s63 offen
  s_add_u32 s60, s88, 7
  s_and_b32 s60, s60, 7
  s_lshl_b32 s65, s49, 3
  s_add_u32 s60, s60, s65
  s_mul_i32 s63, s60, 100352
  s_mul_i32 s65, s48, 50176
  s_add_u32 s63, s63, s65
  buffer_load_dwordx4 v[212:215], v240, s[20:23], s63 offen
  s_add_u32 s63, s63, 7168
  buffer_load_dwordx4 v[216:219], v240, s[20:23], s63 offen
  s_add_u32 s63, s63, 7168
  buffer_load_dwordx4 v[220:223], v240, s[20:23], s63 offen
  s_add_u32 s63, s63, 7168
  buffer_load_dwordx4 v[224:227], v240, s[20:23], s63 offen
  s_add_u32 s63, s63, 7168
  buffer_load_dwordx4 v[228:231], v240, s[20:23], s63 offen
  s_add_u32 s63, s63, 7168
  buffer_load_dwordx4 v[232:235], v240, s[20:23], s63 offen
  s_add_u32 s63, s63, 7168
  buffer_load_dwordx4 v[236:239], v240, s[20:23], s63 offen
  v_add_u32 v40, s61, v6
  v_add_u32 v41, 86016, v40
  s_mul_i32 s61, s49, 14336
  s_mul_i32 s65, s48, 7168
  s_add_u32 s61, s61, s65
  v_add_u32 v42, s61, v6
  s_waitcnt vmcnt(28)
  s_barrier
  s_waitcnt vmcnt(21)
  ds_write_b128 v40, v[72:75] offset:0
  ds_write_b128 v40, v[76:79] offset:1024
  ds_write_b128 v40, v[80:83] offset:2048
  ds_write_b128 v40, v[84:87] offset:3072
  ds_write_b128 v40, v[88:91] offset:4096
  ds_write_b128 v40, v[92:95] offset:5120
  ds_write_b128 v40, v[96:99] offset:6144
  ds_write_b128 v40, v[100:103] offset:7168
  ds_write_b128 v40, v[104:107] offset:8192
  ds_write_b128 v40, v[108:111] offset:9216
  ds_write_b128 v40, v[112:115] offset:10240
  ds_write_b128 v40, v[116:119] offset:11264
  ds_write_b128 v40, v[120:123] offset:12288
  ds_write_b128 v40, v[124:127] offset:13312
  ds_write_b128 v42, v[128:131] offset:57344
  ds_write_b128 v42, v[132:135] offset:58368
  ds_write_b128 v42, v[136:139] offset:59392
  ds_write_b128 v42, v[140:143] offset:60416
  ds_write_b128 v42, v[144:147] offset:61440
  ds_write_b128 v42, v[148:151] offset:62464
  ds_write_b128 v42, v[152:155] offset:63488
  s_waitcnt lgkmcnt(0)
  s_barrier
  s_waitcnt vmcnt(0)
  ds_write_b128 v41, v[156:159] offset:0
  ds_write_b128 v41, v[160:163] offset:1024
  ds_write_b128 v41, v[164:167] offset:2048
  ds_write_b128 v41, v[168:171] offset:3072
  ds_write_b128 v41, v[172:175] offset:4096
  ds_write_b128 v41, v[176:179] offset:5120
  ds_write_b128 v41, v[180:183] offset:6144
  ds_write_b128 v41, v[184:187] offset:7168
  ds_write_b128 v41, v[188:191] offset:8192
  ds_write_b128 v41, v[192:195] offset:9216
  ds_write_b128 v41, v[196:199] offset:10240
  ds_write_b128 v41, v[200:203] offset:11264
  ds_write_b128 v41, v[204:207] offset:12288
  ds_write_b128 v41, v[208:211] offset:13312
  s_waitcnt lgkmcnt(0)
  s_barrier
  ds_write_b128 v42, v[212:215] offset:0
  ds_write_b128 v42, v[216:219] offset:1024
  ds_write_b128 v42, v[220:223] offset:2048
  ds_write_b128 v42, v[224:227] offset:3072
  ds_write_b128 v42, v[228:231] offset:4096
  ds_write_b128 v42, v[232:235] offset:5120
  ds_write_b128 v42, v[236:239] offset:6144
  s_waitcnt lgkmcnt(0)
  s_barrier
  s_barrier
Lend:
  s_endpgm
Lcode_end:
.section .rodata,"a"
.p2align 6
.amdhsa_kernel sequential_preLN__sliding_block__dense_activation_relu__prompt_kernel
  .amdhsa_next_free_vgpr 256
  .amdhsa_next_free_sgpr 102
  .amdhsa_accum_offset 256
  .amdhsa_group_segment_fixed_size 0
  .amdhsa_kernarg_size 72
  .amdhsa_user_sgpr_count 2
  .amdhsa_user_sgpr_kernarg_segment_ptr 1
  .amdhsa_system_sgpr_workgroup_id_x 1
.end_amdhsa_kernel
```
